```python
import torch

def _softmax(x, axis=-1):
    return torch.softmax(x, dim=axis)
def _gelu(x):
    return torch.nn.functional.gelu(x, approximate="tanh")
def _silu(x):
    return torch.nn.functional.silu(x)
def _sigmoid(x):
    return torch.sigmoid(x)
def _layernorm(x, axis=-1, eps=1e-5):
    m = x.mean(dim=axis, keepdim=True)
    v = x.var(dim=axis, keepdim=True, unbiased=False)
    return (x - m) / torch.sqrt(v + eps)
def _scatter_add(tgt, idx, src, axis=0):
    return tgt.clone().index_add_(axis, idx, src)
def _segment_sum(src, seg, n):
    out = torch.zeros((n,) + src.shape[1:], dtype=src.dtype)
    return out.index_add_(0, seg, src)
def _pad(x, pw):
    flat = tuple(v for pair in reversed(pw) for v in pair)
    return torch.nn.functional.pad(x, flat)

kernel_name = 'interleave_layers__linear_attn_block__glu_gated_swiglu__prompt'

def setup_inputs():

    _w = (lambda a: (lambda t: t.to(torch.bfloat16) if t.is_floating_point() else t)(torch.as_tensor(a)))
    def _A_setup():
        B, S, D = 1, 2048, 512
        return {
            "x": _w((lambda *s: torch.randn(*s, dtype=torch.bfloat16) * 0.05)(B, S, D)),
            "wqkv": _w((lambda *s: torch.randn(*s, dtype=torch.bfloat16) * 0.05)(D, 3 * D)),
            "wo": _w((lambda *s: torch.randn(*s, dtype=torch.bfloat16) * 0.05)(D, D)),
        }
    _A_in = _A_setup()

    def _B_setup():
        B, S, D, F = 1, 2048, 512, 1792
        return {
            "x": _w((lambda *s: torch.randn(*s, dtype=torch.bfloat16) * 0.05)(B, S, D)),
            "w1": _w((lambda *s: torch.randn(*s, dtype=torch.bfloat16) * 0.4)(D, F) * (2.0 / D) ** 0.5),
            "w3": _w((lambda *s: torch.randn(*s, dtype=torch.bfloat16) * 0.4)(D, F) * (2.0 / D) ** 0.5),
            "w2": _w((lambda *s: torch.randn(*s, dtype=torch.bfloat16) * 0.4)(F, D) * (2.0 / F) ** 0.5),
        }
    _B_in = _B_setup()

    return {
        "A_x": _A_in["x"],
        "A_wqkv": _A_in["wqkv"],
        "A_wo": _A_in["wo"],
        "B_x": _B_in["x"],
        "B_w1": _B_in["w1"],
        "B_w3": _B_in["w3"],
        "B_w2": _B_in["w2"],
    }

def reference(A_x, A_wqkv, A_wo, B_x, B_w1, B_w3, B_w2):
    def _A_ref(x, wqkv, wo):
        B, S, D = x.shape
        H = 32; Dh = D // H
        qkv = (lambda x, *d: x.permute(*d))((x @ wqkv).reshape(B, S, 3, H, Dh), 2, 0, 3, 1, 4)
        q, k, v = qkv[0], qkv[1], qkv[2]
        phi = lambda t: torch.where(t > 0, t + 1, torch.exp(t)) + 1e-6
        pq, pk = phi(q), phi(k)
        kv = torch.einsum("bhsd,bhse->bhde", pk, v)
        z = torch.einsum("bhsd->bhd", pk)
        num = torch.einsum("bhqd,bhde->bhqe", pq, kv)
        den = torch.einsum("bhqd,bhd->bhq", pq, z)[..., None] + 1e-6
        o = num / den
        return (lambda x, *d: x.permute(*d))(o, 0, 2, 1, 3).reshape(B, S, D) @ wo

    def _B_ref(x, w1, w3, w2):
        gate = torch.einsum("bsd,df->bsf", x, w1)
        up = torch.einsum("bsd,df->bsf", x, w3)
        h = _silu(gate) * up
        out = torch.einsum("bsf,fd->bsd", h, w2)
        return out

    x = A_x
    x = x + _A_ref(_layernorm(x, axis=-1), A_wqkv, A_wo)
    x = x + _B_ref(_layernorm(x, axis=-1), B_w1, B_w3, B_w2)
    x = x + _A_ref(_layernorm(x, axis=-1), A_wqkv, A_wo)
    x = x + _B_ref(_layernorm(x, axis=-1), B_w1, B_w3, B_w2)
    return x
```

```asm
; @launch grid=(256,1,1) block=(256,1,1) lds=163840
.amdgcn_target "amdgcn-amd-amdhsa--gfx950"
.text
.globl interleave_layers__linear_attn_block__glu_gated_swiglu__prompt_kernel
.p2align 8
.type interleave_layers__linear_attn_block__glu_gated_swiglu__prompt_kernel,@function
interleave_layers__linear_attn_block__glu_gated_swiglu__prompt_kernel:
    s_cmp_ge_u32 s2, 256
    s_cbranch_scc1 L_end
    s_load_dwordx16 s[32:47], s[0:1], 0
    s_load_dwordx4 s[48:51], s[0:1], 64
    v_and_b32 v3, 63, v0
    v_lshrrev_b32 v5, 6, v0
    s_nop 0
    v_readfirstlane_b32 s18, v5
    v_lshlrev_b32 v8, 4, v3
    s_cmp_eq_u32 s18, 2
    s_cbranch_scc0 L_skip_1
    s_getpc_b64 s[76:77]
L_pc1:
    s_sub_u32 s76, s76, L_pc1-interleave_layers__linear_attn_block__glu_gated_swiglu__prompt_kernel
    s_subb_u32 s77, s77, 0
    s_lshr_b32 s20, s2, 3
    s_lshl_b32 s20, s20, 10
    v_add_u32 v5, s20, v8
    s_mov_b32 s21, L_codeend-interleave_layers__linear_attn_block__glu_gated_swiglu__prompt_kernel-16
    v_min_u32 v6, s21, v5
    global_load_dwordx4 v[246:249], v6, s[76:77]
L_skip_1:
    s_and_b32 s20, s2, 7
    s_lshr_b32 s21, s2, 3
    s_lshr_b32 s22, s20, 2
    s_lshl_b32 s22, s22, 3
    s_lshr_b32 s23, s21, 2
    s_add_u32 s16, s22, s23
    s_and_b32 s22, s20, 3
    s_lshl_b32 s22, s22, 2
    s_and_b32 s23, s21, 3
    s_add_u32 s17, s22, s23
    s_mov_b32 s19, 0
    s_mov_b32 s57, 0
    v_lshlrev_b32 v0, 4, v3
    v_add_u32 v1, 65536, v0
    v_add_u32 v2, 131072, v0
    v_mov_b32 v4, 1
    v_and_b32 v7, 31, v3
    v_lshlrev_b32 v7, 4, v7
    s_mov_b32 s60, 4294901760
    s_mov_b32 s61, 4294901760
    s_mov_b32 s62, 0
    s_mov_b32 s63, -1
    s_waitcnt lgkmcnt(0)
    s_mov_b32 s4, s50
    s_mov_b32 s5, s51
    s_mov_b32 s6, 268435456
    s_mov_b32 s7, 131072
    s_mov_b32 s8, s46
    s_mov_b32 s9, s47
    s_mov_b32 s10, 2097152
    s_mov_b32 s11, 131072
    s_mov_b32 s12, s32
    s_mov_b32 s13, s33
    s_mov_b32 s14, 2097152
    s_mov_b32 s15, 131072
    s_mov_b32 s52, s48
    s_mov_b32 s53, s49
    s_mov_b32 s54, 256
    s_mov_b32 s55, 131072
    s_cmp_eq_u32 s18, 3
    s_cbranch_scc0 L_skip_2
    v_min_u32 v5, 19, v3
    v_lshlrev_b32 v5, 21, v5
    v_add_u32 v5, 2031616, v5
    buffer_load_dword v250, v5, s[4:7], 0 offen
L_skip_2:
    s_xor_b32 s20, s16, 4
    s_or_b32 s20, s20, s17
    s_or_b32 s20, s20, s18
    s_cmp_eq_u32 s20, 0
    s_cbranch_scc0 L_skip_3
    v_mov_b32 v80, 0
    v_mov_b32 v81, 0
    v_mov_b32 v82, 0
    v_mov_b32 v83, 0
    v_lshrrev_b32 v5, 3, v3
    v_lshlrev_b32 v5, 8, v5
    v_and_b32 v6, 7, v3
    v_lshlrev_b32 v6, 4, v6
    v_add_u32 v5, v5, v6
    s_mov_b32 s21, 0
    buffer_store_dwordx4 v[80:83], v5, s[4:7], s21 offen sc1
    s_mov_b32 s21, 2048
    buffer_store_dwordx4 v[80:83], v5, s[4:7], s21 offen sc1
    s_mov_b32 s21, 4096
    buffer_store_dwordx4 v[80:83], v5, s[4:7], s21 offen sc1
    s_mov_b32 s21, 6144
    buffer_store_dwordx4 v[80:83], v5, s[4:7], s21 offen sc1
    s_waitcnt vmcnt(0)
    v_lshlrev_b32 v5, 4, v3
    v_cmp_eq_u32 vcc, 0, v3
    s_nop 1
    v_cndmask_b32 v80, v80, v4, vcc
    s_mov_b64 exec, 255
    buffer_store_dwordx4 v[80:83], v5, s[52:55], 0 offen sc1
    s_mov_b64 exec, -1
L_skip_3:
    s_lshr_b32 s20, s17, 2
    s_lshl_b32 s66, s16, 2
    s_add_u32 s66, s66, s20
    s_and_b32 s20, s17, 3
    s_lshl_b32 s67, s20, 2
    s_add_u32 s67, s67, s18
    v_and_b32 v16, 31, v3
    v_lshlrev_b32 v16, 10, v16
    v_lshrrev_b32 v5, 5, v3
    v_lshlrev_b32 v5, 3, v5
    v_add_u32 v16, v16, v5
    s_lshl_b32 s20, s66, 15
    s_lshl_b32 s21, s67, 6
    s_add_u32 s20, s20, s21
    buffer_load_dwordx2 v[8:9], v16, s[12:15], s20 offen
    buffer_load_dwordx2 v[10:11], v16, s[12:15], s20 offen offset:16
    buffer_load_dwordx2 v[12:13], v16, s[12:15], s20 offen offset:32
    buffer_load_dwordx2 v[14:15], v16, s[12:15], s20 offen offset:48
    s_mov_b32 s68, 1
    s_mov_b32 s100, 1
    s_lshl_b32 s69, s16, 4
    s_add_u32 s69, s69, s17
    s_cmp_lt_u32 s16, 4
    s_cbranch_scc1 L_q1_4
    s_sub_u32 s69, s16, 12
    s_lshl_b32 s69, s69, 3
    s_add_u32 s69, s69, s17
    s_add_u32 s69, s69, 64
    s_cmp_ge_u32 s16, 12
    s_cselect_b32 s100, 1, 0
    s_cmp_lt_u32 s17, 8
    s_cselect_b32 s68, s100, 0
L_q1_4:
    s_lshr_b32 s70, s69, 5
    s_lshr_b32 s71, s69, 2
    s_and_b32 s71, s71, 7
    s_and_b32 s72, s69, 3
    s_mov_b32 s76, s34
    s_mov_b32 s77, s35
    s_mov_b32 s78, 1572864
    s_mov_b32 s79, 131072
    s_mov_b32 s59, 3072
    s_lshl_b32 s29, s70, 9
    s_lshl_b32 s21, s71, 6
    s_add_u32 s29, s29, s21
    s_lshl_b32 s20, s71, 1
    s_mul_i32 s20, s20, 3
    s_add_u32 s20, s20, s70
    s_lshl_b32 s64, s20, 15
    s_add_u32 s64, s64, 1048576
    s_add_u32 s65, s64, 98304
    s_add_u32 s3, s71, 16
    s_cmp_lg_u32 s68, 0
    s_cbranch_scc1 L_q2_5
    s_mov_b32 s76, s36
    s_mov_b32 s77, s37
    s_mov_b32 s78, 524288
    s_mov_b32 s79, 131072
    s_mov_b32 s59, 1024
    s_and_b32 s20, s17, 7
    s_lshl_b32 s29, s20, 6
    s_add_u32 s3, s20, 24
    s_lshl_b32 s64, s20, 16
    s_add_u32 s64, s64, 3145728
    s_add_u32 s65, s64, 32768
    s_sub_u32 s72, s16, 12
    s_and_b32 s72, s72, 3
L_q2_5:
    s_lshl_b32 s20, s72, 3
    s_lshl_b32 s21, s18, 1
    s_add_u32 s20, s20, s21
    s_lshl_b32 s20, s20, 10
    s_add_u32 s64, s64, s20
    s_add_u32 s65, s65, s20
    v_lshrrev_b32 v23, 3, v3
    v_and_b32 v22, 7, v3
    v_lshlrev_b32 v22, 4, v22
    s_cmp_lg_u32 s100, 0
    s_cbranch_scc0 L_skip_7
    v_mul_u32_u24 v17, s59, v23
    v_add_u32 v17, v17, v22
    s_lshl_b32 s20, s29, 1
    v_add_u32 v17, s20, v17
    s_lshl_b32 s20, s72, 7
    s_lshl_b32 s21, s18, 5
    s_add_u32 s20, s20, s21
    s_mul_i32 s73, s20, s59
    s_lshl_b32 s20, s59, 3
    s_lshl_b32 s21, s18, 12
    s_add_u32 s21, s21, 0
    s_mov_b32 m0, s21
    s_nop 0
    buffer_load_dwordx4 v17, s[76:79], s73 offen lds
    s_add_u32 s73, s73, s20
    s_add_u32 s21, s21, 1024
    s_mov_b32 m0, s21
    s_nop 0
    buffer_load_dwordx4 v17, s[76:79], s73 offen lds
    s_add_u32 s73, s73, s20
    s_add_u32 s21, s21, 1024
    s_mov_b32 m0, s21
    s_nop 0
    buffer_load_dwordx4 v17, s[76:79], s73 offen lds
    s_add_u32 s73, s73, s20
    s_add_u32 s21, s21, 1024
    s_mov_b32 m0, s21
    s_nop 0
    buffer_load_dwordx4 v17, s[76:79], s73 offen lds
L_skip_7:
    s_mov_b32 s80, 0
    s_mov_b32 s81, 2
    s_mov_b32 s98, 0
    s_mov_b32 s99, 0
    s_mov_b32 s84, s36
    s_mov_b32 s85, s37
    s_mov_b32 s86, 524288
    s_mov_b32 s87, 131072
    s_mov_b32 s88, s36
    s_mov_b32 s89, s37
    s_mov_b32 s90, 524288
    s_mov_b32 s91, 131072
    s_mov_b32 s82, 1024
    s_mov_b32 s27, 0
    s_mov_b32 s28, 0
    s_mov_b32 s83, 0
    s_mov_b32 s97, 0
    s_cmp_ge_u32 s16, 12
    s_cbranch_scc1 L_uW2_8
    s_cmp_ge_u32 s16, 4
    s_cbranch_scc1 L_uW13_9
    s_branch L_uE_10
L_uW2_8:
    s_lshr_b32 s21, s17, 3
    s_lshl_b32 s21, s21, 2
    s_add_u32 s99, s21, s16
    s_sub_u32 s99, s99, 12
    s_cmp_ge_u32 s99, 7
    s_cbranch_scc1 L_uE_10
    s_mov_b32 s80, 1
    s_mov_b32 s81, 4
    s_mov_b32 s84, s44
    s_mov_b32 s85, s45
    s_mov_b32 s86, 1835008
    s_mov_b32 s87, 131072
    s_mov_b32 s88, s44
    s_mov_b32 s89, s45
    s_mov_b32 s90, 1835008
    s_mov_b32 s91, 131072
    s_and_b32 s20, s17, 7
    s_lshl_b32 s27, s20, 6
    s_lshl_b32 s28, s99, 8
    s_lshl_b32 s21, s18, 6
    s_add_u32 s28, s28, s21
    s_mul_i32 s83, s20, 229376
    s_lshl_b32 s21, s99, 4
    s_lshl_b32 s20, s18, 2
    s_add_u32 s21, s21, s20
    s_lshl_b32 s21, s21, 10
    s_add_u32 s83, s83, s21
    s_add_u32 s83, s83, 8388608
    s_add_u32 s97, s83, 114688
    s_branch L_uE_10
L_uW13_9:
    s_mov_b32 s80, 2
    s_sub_u32 s20, s16, 4
    s_lshr_b32 s98, s20, 2
    s_and_b32 s99, s20, 3
    s_mov_b32 s84, s40
    s_mov_b32 s85, s41
    s_mov_b32 s86, 1835008
    s_mov_b32 s87, 131072
    s_mov_b32 s88, s42
    s_mov_b32 s89, s43
    s_mov_b32 s90, 1835008
    s_mov_b32 s91, 131072
    s_mov_b32 s82, 3584
    s_mul_i32 s27, s17, 112
    s_lshl_b32 s21, s98, 6
    s_add_u32 s27, s27, s21
    s_lshl_b32 s28, s99, 7
    s_lshl_b32 s21, s18, 5
    s_add_u32 s28, s28, s21
    s_mul_i32 s83, s17, 7
    s_lshl_b32 s21, s98, 2
    s_add_u32 s83, s83, s21
    s_lshl_b32 s83, s83, 15
    s_lshl_b32 s21, s99, 3
    s_lshl_b32 s20, s18, 1
    s_add_u32 s21, s21, s20
    s_lshl_b32 s21, s21, 10
    s_add_u32 s83, s83, s21
    s_add_u32 s83, s83, 4194304
L_uE_10:
    s_cmp_lg_u32 s80, 0
    s_cbranch_scc0 L_skip_11
    v_mul_u32_u24 v18, s82, v23
    v_add_u32 v18, v18, v22
    s_lshl_b32 s20, s27, 1
    v_add_u32 v18, s20, v18
    s_cmp_eq_u32 s81, 4
    s_cselect_b32 s20, 6, 5
    s_lshl_b32 s20, s18, s20
    s_sub_u32 s74, s28, s20
L_skip_11:
    v_lshrrev_b32 v19, 5, v3
    v_lshlrev_b32 v19, 2, v19
    v_bfe_u32 v22, v3, 2, 2
    v_add_u32 v19, v19, v22
    v_lshlrev_b32 v19, 7, v19
    v_and_b32 v22, 3, v3
    v_lshlrev_b32 v22, 3, v22
    v_add_u32 v19, v19, v22
    v_bfe_u32 v22, v3, 4, 1
    v_lshlrev_b32 v23, 12, v22
    v_add_u32 v20, v19, v23
    v_lshlrev_b32 v23, 5, v22
    v_add_u32 v19, v19, v23
    v_mov_b32 v244, v19
    v_mov_b32 v245, v20
    s_waitcnt vmcnt(3)
    v_lshlrev_b32 v120, 16, v8
    v_and_b32 v121, 4294901760, v8
    v_lshlrev_b32 v122, 16, v9
    v_and_b32 v123, 4294901760, v9
    s_waitcnt vmcnt(2)
    v_lshlrev_b32 v124, 16, v10
    v_and_b32 v125, 4294901760, v10
    v_lshlrev_b32 v126, 16, v11
    v_and_b32 v127, 4294901760, v11
    s_waitcnt vmcnt(1)
    v_lshlrev_b32 v128, 16, v12
    v_and_b32 v129, 4294901760, v12
    v_lshlrev_b32 v130, 16, v13
    v_and_b32 v131, 4294901760, v13
    s_waitcnt vmcnt(0)
    v_lshlrev_b32 v132, 16, v14
    v_and_b32 v133, 4294901760, v14
    v_lshlrev_b32 v134, 16, v15
    v_and_b32 v135, 4294901760, v15
    s_lshl_b32 s20, s66, 15
    s_lshl_b32 s21, s67, 11
    s_add_u32 s20, s20, s21
    s_add_u32 s20, s20, 10485760
    s_mov_b32 s23, 0
    s_lshl_b32 s21, s23, 18
    s_lshl_b32 s22, s66, 12
    s_add_u32 s21, s21, s22
    s_lshl_b32 s22, s67, 8
    s_add_u32 s21, s21, s22
    s_add_u32 s21, s21, 18874368
    buffer_store_dwordx4 v[8:11], v0, s[4:7], s20 offen sc1
    buffer_store_dwordx4 v[12:15], v0, s[4:7], s20 offen offset:1024 sc1
    v_pk_mul_f32 v[140:141], v[120:121], v[120:121]
    v_pk_mul_f32 v[142:143], v[122:123], v[122:123]
    v_pk_add_f32 v[136:137], v[120:121], v[122:123]
    v_pk_add_f32 v[138:139], v[124:125], v[126:127]
    v_pk_fma_f32 v[140:141], v[124:125], v[124:125], v[140:141]
    v_pk_fma_f32 v[142:143], v[126:127], v[126:127], v[142:143]
    v_pk_fma_f32 v[140:141], v[128:129], v[128:129], v[140:141]
    v_pk_add_f32 v[136:137], v[136:137], v[128:129]
    v_pk_add_f32 v[138:139], v[138:139], v[130:131]
    v_pk_fma_f32 v[142:143], v[130:131], v[130:131], v[142:143]
    v_pk_fma_f32 v[140:141], v[132:133], v[132:133], v[140:141]
    v_pk_add_f32 v[136:137], v[136:137], v[132:133]
    v_pk_add_f32 v[138:139], v[138:139], v[134:135]
    v_pk_fma_f32 v[142:143], v[134:135], v[134:135], v[142:143]
    v_pk_add_f32 v[136:137], v[136:137], v[138:139]
    v_pk_add_f32 v[140:141], v[140:141], v[142:143]
    v_add_f32 v152, v136, v137
    v_add_f32 v153, v140, v141
    v_mov_b32 v136, v152
    v_mov_b32 v137, v153
    s_nop 0
    v_permlane32_swap_b32 v152, v136
    v_permlane32_swap_b32 v153, v137
    v_add_f32 v152, v152, v136
    v_add_f32 v153, v153, v137
    v_lshrrev_b32 v136, 1, v7
    buffer_store_dwordx2 v[152:153], v136, s[4:7], s21 offen sc1
    s_cmp_lg_u32 s100, 0
    s_cbranch_scc0 L_skip_12
    s_lshl_b32 s20, s18, 12
    s_add_u32 s20, s20, 0
    v_add_u32 v79, s20, v19
    s_waitcnt vmcnt(3)
    ds_read_b64_tr_b16 v[24:25], v79
    ds_read_b64_tr_b16 v[26:27], v79 offset:1024
    ds_read_b64_tr_b16 v[28:29], v79 offset:64
    ds_read_b64_tr_b16 v[30:31], v79 offset:1088
    ds_read_b64_tr_b16 v[32:33], v79 offset:2048
    ds_read_b64_tr_b16 v[34:35], v79 offset:3072
    ds_read_b64_tr_b16 v[36:37], v79 offset:2112
    ds_read_b64_tr_b16 v[38:39], v79 offset:3136
    s_waitcnt lgkmcnt(6)
    buffer_store_dwordx4 v[24:27], v0, s[4:7], s64 offen sc1
    s_waitcnt lgkmcnt(4)
    buffer_store_dwordx4 v[28:31], v0, s[4:7], s65 offen sc1
    s_waitcnt lgkmcnt(2)
    buffer_store_dwordx4 v[32:35], v0, s[4:7], s64 offen offset:1024 sc1
    s_waitcnt lgkmcnt(0)
    buffer_store_dwordx4 v[36:39], v0, s[4:7], s65 offen offset:1024 sc1
L_skip_12:
    s_cmp_lg_u32 s68, 0
    s_cbranch_scc0 L_skip_13
    v_mov_b32 v40, 1065369472
    v_mov_b32 v41, 1065369472
    v_mov_b32 v42, 1065369472
    v_mov_b32 v43, 1065369472
    s_nop 1
    v_mfma_f32_32x32x16_bf16 v[44:59], v[40:43], v[24:27], 0
    v_mfma_f32_32x32x16_bf16 v[60:75], v[40:43], v[28:31], 0
    v_mfma_f32_32x32x16_bf16 v[44:59], v[40:43], v[32:35], v[44:59]
    v_mfma_f32_32x32x16_bf16 v[60:75], v[40:43], v[36:39], v[60:75]
    s_nop 11
    v_cndmask_b32 v76, v44, v60, s[62:63]
    s_lshl_b32 s20, s18, 8
    s_add_u32 s20, s20, 155648
    v_lshlrev_b32 v78, 2, v3
    v_add_u32 v77, s20, v78
    ds_write_b32 v77, v76
    s_waitcnt lgkmcnt(0)
    s_barrier
    s_cmp_eq_u32 s18, 0
    s_cbranch_scc0 L_skip_14
    v_add_u32 v77, 155648, v78
    ds_read_b32 v104, v77
    ds_read_b32 v105, v77 offset:256
    ds_read_b32 v106, v77 offset:512
    ds_read_b32 v107, v77 offset:768
    s_waitcnt lgkmcnt(2)
    v_add_f32 v104, v104, v105
    s_waitcnt lgkmcnt(0)
    v_add_f32 v106, v106, v107
    v_add_f32 v104, v104, v106
    s_lshl_b32 s20, s70, 3
    s_add_u32 s20, s20, s71
    s_lshl_b32 s20, s20, 2
    s_add_u32 s20, s20, s72
    s_lshl_b32 s20, s20, 8
    s_add_u32 s20, s20, 2621440
    buffer_store_dword v104, v78, s[4:7], s20 offen sc1
L_skip_14:
L_skip_13:
    s_or_b32 s20, s17, s18
    s_cmp_eq_u32 s20, 0
    s_cbranch_scc0 L_skip_15
    v_mov_b32 v80, 0
    v_mov_b32 v81, 0
    v_mov_b32 v82, 0
    v_mov_b32 v83, 0
    v_and_b32 v85, 7, v3
    v_lshlrev_b32 v85, 4, v85
    v_lshrrev_b32 v84, 3, v3
    v_cmp_gt_u32 vcc, 6, v84
    v_mov_b32 v5, 16
    v_mov_b32 v6, 0
    v_cndmask_b32 v5, v5, v6, vcc
    v_lshlrev_b32 v6, 4, v84
    v_add_u32 v5, v5, v6
    v_add_u32 v5, 48, v5
    v_add_u32 v5, s16, v5
    v_lshlrev_b32 v5, 8, v5
    v_add_u32 v5, v5, v85
    buffer_store_dwordx4 v[80:83], v5, s[4:7], 0 offen sc1
    v_lshrrev_b32 v84, 3, v3
    v_add_u32 v84, 8, v84
    v_cmp_gt_u32 vcc, 6, v84
    v_mov_b32 v5, 16
    v_mov_b32 v6, 0
    v_cndmask_b32 v5, v5, v6, vcc
    v_lshlrev_b32 v6, 4, v84
    v_add_u32 v5, v5, v6
    v_add_u32 v5, 48, v5
    v_add_u32 v5, s16, v5
    v_lshlrev_b32 v5, 8, v5
    v_add_u32 v5, v5, v85
    s_mov_b32 exec_hi, 0
    buffer_store_dwordx4 v[80:83], v5, s[4:7], 0 offen sc1
    s_mov_b32 exec_hi, -1
L_skip_15:
    s_or_b32 s20, s70, s72
    s_or_b32 s20, s20, s18
    s_xor_b32 s21, s68, 1
    s_or_b32 s20, s20, s21
    s_cmp_eq_u32 s20, 0
    s_cbranch_scc0 L_skip_16
    v_mov_b32 v80, 0
    v_mov_b32 v81, 0
    v_mov_b32 v82, 0
    v_mov_b32 v83, 0
    v_lshrrev_b32 v84, 3, v3
    v_and_b32 v85, 7, v3
    v_lshlrev_b32 v85, 4, v85
    v_lshrrev_b32 v5, 1, v84
    v_mul_u32_u24 v5, 112, v5
    v_and_b32 v6, 1, v84
    v_add_u32 v5, v5, v6
    s_lshl_b32 s20, s71, 1
    s_add_u32 s20, s20, 32
    v_add_u32 v5, s20, v5
    v_lshlrev_b32 v5, 8, v5
    v_add_u32 v5, v5, v85
    s_mov_b32 exec_hi, 0
    buffer_store_dwordx4 v[80:83], v5, s[4:7], 0 offen sc1
    s_mov_b32 exec_hi, -1
L_skip_16:
    s_cmp_eq_u32 s18, 0
    s_cbranch_scc0 L_skip_17
    s_mov_b64 exec, 1
    buffer_load_dword v21, off, s[52:55], 0 sc1
    s_mov_b64 exec, -1
L_skip_17:
    s_waitcnt vmcnt(0) lgkmcnt(0)
    s_barrier
    s_cmp_eq_u32 s18, 0
    s_cbranch_scc0 L_skip_18
    v_readfirstlane_b32 s30, v21
    s_nop 0
    s_cmp_lg_u32 s30, 0
    s_cbranch_scc1 L_iok_19
    s_mov_b64 exec, 1
    s_mov_b32 s56, 0
L_ip_20:
    buffer_load_dword v5, off, s[52:55], 0 sc1
    s_add_u32 s56, s56, 1
    s_waitcnt vmcnt(0)
    v_readfirstlane_b32 s30, v5
    s_nop 0
    s_cmp_lg_u32 s30, 0
    s_cbranch_scc1 L_iok_19
    s_cmp_lt_u32 s56, 131072
    s_cbranch_scc1 L_ip_20
    s_mov_b32 s57, 1
L_iok_19:
    s_mov_b64 exec, 1
    s_lshl_b32 s20, s16, 8
    buffer_atomic_add v4, off, s[4:7], s20
    s_cmp_lg_u32 s100, 0
    s_cbranch_scc0 L_skip_21
    s_lshl_b32 s20, s3, 8
    buffer_atomic_add v4, off, s[4:7], s20
L_skip_21:
    s_mov_b64 exec, -1
L_skip_18:
    s_cmp_lg_u32 s80, 0
    s_cbranch_scc0 L_skip_22
    s_cmp_lg_u32 s18, 0
    s_cbranch_scc0 L_skip_23
    s_lshl_b32 s22, s82, 5
    s_cmp_eq_u32 s81, 4
    s_cselect_b32 s23, 1, 0
    s_lshl_b32 s23, s22, s23
    s_mul_i32 s101, s74, s82
    s_mul_i32 s23, s23, s18
    s_add_u32 s101, s101, s23
    s_lshl_b32 s21, s18, 13
    s_add_u32 s21, s21, 114688
    s_add_u32 s75, s22, s101
    s_cmp_eq_u32 s81, 4
    s_cselect_b32 s75, s75, s101
    s_lshl_b32 s20, s82, 3
    s_mov_b32 m0, s21
    s_nop 0
    buffer_load_dwordx4 v18, s[84:87], s101 offen lds
    s_add_u32 s101, s101, s20
    s_add_u32 s21, s21, 1024
    s_mov_b32 m0, s21
    s_nop 0
    buffer_load_dwordx4 v18, s[84:87], s101 offen lds
    s_add_u32 s101, s101, s20
    s_add_u32 s21, s21, 1024
    s_mov_b32 m0, s21
    s_nop 0
    buffer_load_dwordx4 v18, s[84:87], s101 offen lds
    s_add_u32 s101, s101, s20
    s_add_u32 s21, s21, 1024
    s_mov_b32 m0, s21
    s_nop 0
    buffer_load_dwordx4 v18, s[84:87], s101 offen lds
    s_add_u32 s101, s101, s20
    s_add_u32 s21, s21, 1024
    s_mov_b32 m0, s21
    s_nop 0
    buffer_load_dwordx4 v18, s[88:91], s75 offen lds
    s_add_u32 s75, s75, s20
    s_add_u32 s21, s21, 1024
    s_mov_b32 m0, s21
    s_nop 0
    buffer_load_dwordx4 v18, s[88:91], s75 offen lds
    s_add_u32 s75, s75, s20
    s_add_u32 s21, s21, 1024
    s_mov_b32 m0, s21
    s_nop 0
    buffer_load_dwordx4 v18, s[88:91], s75 offen lds
    s_add_u32 s75, s75, s20
    s_add_u32 s21, s21, 1024
    s_mov_b32 m0, s21
    s_nop 0
    buffer_load_dwordx4 v18, s[88:91], s75 offen lds
L_skip_23:
    s_cmp_eq_u32 s18, 3
    s_cbranch_scc0 L_skip_24
    s_lshl_b32 s22, s82, 5
    s_cmp_eq_u32 s81, 4
    s_cselect_b32 s23, 1, 0
    s_lshl_b32 s23, s22, s23
    s_mul_i32 s101, s74, s82
    s_mov_b32 s21, 114688
    s_add_u32 s75, s22, s101
    s_cmp_eq_u32 s81, 4
    s_cselect_b32 s75, s75, s101
    s_lshl_b32 s20, s82, 3
    s_mov_b32 m0, s21
    s_nop 0
    buffer_load_dwordx4 v18, s[84:87], s101 offen lds
    s_add_u32 s101, s101, s20
    s_add_u32 s21, s21, 1024
    s_mov_b32 m0, s21
    s_nop 0
    buffer_load_dwordx4 v18, s[84:87], s101 offen lds
    s_add_u32 s101, s101, s20
    s_add_u32 s21, s21, 1024
    s_mov_b32 m0, s21
    s_nop 0
    buffer_load_dwordx4 v18, s[84:87], s101 offen lds
    s_add_u32 s101, s101, s20
    s_add_u32 s21, s21, 1024
    s_mov_b32 m0, s21
    s_nop 0
    buffer_load_dwordx4 v18, s[84:87], s101 offen lds
    s_add_u32 s101, s101, s20
    s_add_u32 s21, s21, 1024
    s_mov_b32 m0, s21
    s_nop 0
    buffer_load_dwordx4 v18, s[88:91], s75 offen lds
    s_add_u32 s75, s75, s20
    s_add_u32 s21, s21, 1024
    s_mov_b32 m0, s21
    s_nop 0
    buffer_load_dwordx4 v18, s[88:91], s75 offen lds
    s_add_u32 s75, s75, s20
    s_add_u32 s21, s21, 1024
    s_mov_b32 m0, s21
    s_nop 0
    buffer_load_dwordx4 v18, s[88:91], s75 offen lds
    s_add_u32 s75, s75, s20
    s_add_u32 s21, s21, 1024
    s_mov_b32 m0, s21
    s_nop 0
    buffer_load_dwordx4 v18, s[88:91], s75 offen lds
L_skip_24:
L_skip_22:
    s_cmp_eq_u32 s18, 0
    s_cbranch_scc0 L_skip_25
    s_lshl_b32 s58, s16, 8
    s_mov_b64 exec, 1
    s_mov_b32 s56, 0
L_poll_26:
    buffer_load_dword v5, off, s[4:7], s58 sc1
    s_add_u32 s56, s56, 1
    s_waitcnt vmcnt(0)
    v_readfirstlane_b32 s30, v5
    s_nop 0
    s_cmp_ge_u32 s30, 16
    s_cbranch_scc1 L_got_27
    s_cmp_lt_u32 s56, 262144
    s_cbranch_scc1 L_poll_26
    s_mov_b32 s57, 1
L_got_27:
    s_mov_b64 exec, -1
    s_lshr_b32 s58, s17, 1
    s_add_u32 s58, s58, 16
    s_lshl_b32 s58, s58, 8
    s_mov_b64 exec, 1
    s_mov_b32 s56, 0
L_poll_28:
    buffer_load_dword v5, off, s[4:7], s58 sc1
    s_add_u32 s56, s56, 1
    s_waitcnt vmcnt(0)
    v_readfirstlane_b32 s30, v5
    s_nop 0
    s_cmp_ge_u32 s30, 12
    s_cbranch_scc1 L_got_29
    s_cmp_lt_u32 s56, 262144
    s_cbranch_scc1 L_poll_28
    s_mov_b32 s57, 1
L_got_29:
    s_mov_b64 exec, -1
    s_and_b32 s58, s17, 7
    s_add_u32 s58, s58, 24
    s_lshl_b32 s58, s58, 8
    s_mov_b64 exec, 1
    s_mov_b32 s56, 0
L_poll_30:
    buffer_load_dword v5, off, s[4:7], s58 sc1
    s_add_u32 s56, s56, 1
    s_waitcnt vmcnt(0)
    v_readfirstlane_b32 s30, v5
    s_nop 0
    s_cmp_ge_u32 s30, 4
    s_cbranch_scc1 L_got_31
    s_cmp_lt_u32 s56, 262144
    s_cbranch_scc1 L_poll_30
    s_mov_b32 s57, 1
L_got_31:
    s_mov_b64 exec, -1
L_skip_25:
    s_barrier
L_layer:
    s_cmp_eq_u32 s19, 0
    s_cbranch_scc0 L_skip_32
    s_mul_i32 s21, s17, 98304
    s_lshl_b32 s22, s18, 14
    s_add_u32 s22, s22, 32768
    s_add_u32 s21, s21, s22
    s_add_u32 s21, s21, 1048576
    s_mov_b32 m0, s22
    s_nop 0
    buffer_load_dwordx4 v0, s[4:7], s21 offen sc1 lds
    buffer_load_dwordx4 v0, s[4:7], s21 offen offset:1024 sc1 lds
    buffer_load_dwordx4 v0, s[4:7], s21 offen offset:2048 sc1 lds
    buffer_load_dwordx4 v0, s[4:7], s21 offen offset:3072 sc1 lds
    s_add_u32 s21, s21, 4096
    s_add_u32 s22, s22, 4096
    s_mov_b32 m0, s22
    s_nop 0
    buffer_load_dwordx4 v0, s[4:7], s21 offen sc1 lds
    buffer_load_dwordx4 v0, s[4:7], s21 offen offset:1024 sc1 lds
    buffer_load_dwordx4 v0, s[4:7], s21 offen offset:2048 sc1 lds
    buffer_load_dwordx4 v0, s[4:7], s21 offen offset:3072 sc1 lds
    s_add_u32 s21, s21, 4096
    s_add_u32 s22, s22, 4096
    s_mov_b32 m0, s22
    s_nop 0
    buffer_load_dwordx4 v0, s[4:7], s21 offen sc1 lds
    buffer_load_dwordx4 v0, s[4:7], s21 offen offset:1024 sc1 lds
    buffer_load_dwordx4 v0, s[4:7], s21 offen offset:2048 sc1 lds
    buffer_load_dwordx4 v0, s[4:7], s21 offen offset:3072 sc1 lds
    s_add_u32 s21, s21, 4096
    s_add_u32 s22, s22, 4096
    s_mov_b32 m0, s22
    s_nop 0
    buffer_load_dwordx4 v0, s[4:7], s21 offen sc1 lds
    buffer_load_dwordx4 v0, s[4:7], s21 offen offset:1024 sc1 lds
    buffer_load_dwordx4 v0, s[4:7], s21 offen offset:2048 sc1 lds
    buffer_load_dwordx4 v0, s[4:7], s21 offen offset:3072 sc1 lds
    s_cmp_lt_u32 s18, 3
    s_cbranch_scc0 L_skip_33
    s_lshl_b32 s20, s18, 3
    s_lshr_b32 s21, s17, 1
    s_add_u32 s20, s20, s21
    s_lshl_b32 s20, s20, 10
    s_add_u32 s20, s20, 2621440
    s_and_b32 s21, s17, 1
    s_lshl_b32 s21, s21, 7
    s_add_u32 s20, s20, s21
    v_lshrrev_b32 v17, 2, v7
    buffer_load_dword v8, v17, s[4:7], s20 offen sc1
    buffer_load_dword v9, v17, s[4:7], s20 offen offset:256 sc1
    buffer_load_dword v10, v17, s[4:7], s20 offen offset:512 sc1
    buffer_load_dword v11, v17, s[4:7], s20 offen offset:768 sc1
    s_waitcnt vmcnt(2)
    v_add_f32 v8, v8, v9
    s_waitcnt vmcnt(0)
    v_add_f32 v10, v10, v11
    v_add_f32 v8, v8, v10
    v_cvt_pk_bf16_f32 v12, v8, v8
    v_lshlrev_b32 v16, 16, v12
    v_sub_f32 v16, v8, v16
    v_cvt_pk_bf16_f32 v12, v8, v16
    v_and_b32 v13, 65535, v12
    v_mov_b32 v14, 0
    v_mov_b32 v15, 0
    v_cndmask_b32 v12, v12, v14, s[62:63]
    v_cndmask_b32 v13, v13, v14, s[62:63]
    s_lshl_b32 s20, s18, 10
    s_add_u32 s20, s20, 147456
    v_add_u32 v17, s20, v0
    ds_write_b128 v17, v[12:15]
L_skip_33:
    s_cmp_lg_u32 s18, 0
    s_cbranch_scc0 L_skip_34
    s_sub_u32 s20, s18, 1
    s_mul_i32 s22, s20, 11264
    s_mul_i32 s21, s17, 98304
    s_add_u32 s21, s21, s22
    s_add_u32 s21, s21, 1048576
    s_mov_b32 m0, s22
    s_nop 0
    buffer_load_dwordx4 v0, s[4:7], s21 offen sc1 lds
    buffer_load_dwordx4 v0, s[4:7], s21 offen offset:1024 sc1 lds
    buffer_load_dwordx4 v0, s[4:7], s21 offen offset:2048 sc1 lds
    buffer_load_dwordx4 v0, s[4:7], s21 offen offset:3072 sc1 lds
    s_add_u32 s21, s21, 4096
    s_add_u32 s22, s22, 4096
    s_mov_b32 m0, s22
    s_nop 0
    buffer_load_dwordx4 v0, s[4:7], s21 offen sc1 lds
    buffer_load_dwordx4 v0, s[4:7], s21 offen offset:1024 sc1 lds
    buffer_load_dwordx4 v0, s[4:7], s21 offen offset:2048 sc1 lds
    buffer_load_dwordx4 v0, s[4:7], s21 offen offset:3072 sc1 lds
    s_add_u32 s21, s21, 4096
    s_add_u32 s22, s22, 4096
    s_mov_b32 m0, s22
    s_nop 0
    buffer_load_dwordx4 v0, s[4:7], s21 offen sc1 lds
    buffer_load_dwordx4 v0, s[4:7], s21 offen offset:1024 sc1 lds
    buffer_load_dwordx4 v0, s[4:7], s21 offen offset:2048 sc1 lds
L_skip_34:
L_skip_32:
    s_lshl_b32 s25, s19, 1
    s_lshl_b32 s20, s16, 2
    s_add_u32 s20, s20, s18
    s_lshl_b32 s21, s25, 18
    s_lshl_b32 s22, s20, 12
    s_add_u32 s21, s21, s22
    s_add_u32 s21, s21, 18874368
    s_lshl_b32 s79, s25, 21
    s_lshl_b32 s22, s20, 15
    s_add_u32 s79, s79, s22
    s_add_u32 s79, s79, 10485760
    buffer_load_dwordx4 a[0:3], v0, s[4:7], s79 offen sc1
    buffer_load_dwordx4 a[4:7], v0, s[4:7], s79 offen offset:1024 sc1
    v_and_b32 v5, 3, v3
    v_bfe_u32 v6, v3, 3, 2
    v_lshl_add_u32 v5, v6, 2, v5
    v_lshlrev_b32 v5, 4, v5
    v_bfe_u32 v6, v3, 2, 1
    v_lshl_add_u32 v5, v6, 8, v5
    v_lshrrev_b32 v6, 5, v3
    v_lshl_add_u32 v6, v6, 11, v5
    buffer_load_dwordx4 v[8:11], v6, s[4:7], s21 offen sc1
    buffer_load_dwordx4 v[12:15], v6, s[4:7], s21 offen offset:512 sc1
    buffer_load_dwordx4 v[16:19], v6, s[4:7], s21 offen offset:1024 sc1
    buffer_load_dwordx4 v[20:23], v6, s[4:7], s21 offen offset:1536 sc1
    buffer_load_dwordx4 a[8:11], v0, s[4:7], s79 offen offset:2048 sc1
    buffer_load_dwordx4 a[12:15], v0, s[4:7], s79 offen offset:3072 sc1
    s_add_u32 s79, s79, 4096
    buffer_load_dwordx4 a[16:19], v0, s[4:7], s79 offen sc1
    buffer_load_dwordx4 a[20:23], v0, s[4:7], s79 offen offset:1024 sc1
    buffer_load_dwordx4 a[24:27], v0, s[4:7], s79 offen offset:2048 sc1
    buffer_load_dwordx4 a[28:31], v0, s[4:7], s79 offen offset:3072 sc1
    s_add_u32 s79, s79, 4096
    buffer_load_dwordx4 a[32:35], v0, s[4:7], s79 offen sc1
    buffer_load_dwordx4 a[36:39], v0, s[4:7], s79 offen offset:1024 sc1
    buffer_load_dwordx4 a[40:43], v0, s[4:7], s79 offen offset:2048 sc1
    buffer_load_dwordx4 a[44:47], v0, s[4:7], s79 offen offset:3072 sc1
    s_lshr_b32 s20, s17, 3
    s_lshl_b32 s20, s20, 1
    s_lshl_b32 s21, s16, 2
    s_add_u32 s20, s20, s21
    s_lshr_b32 s21, s18, 1
    s_add_u32 s74, s20, s21
    s_xor_b32 s21, s21, 1
    s_add_u32 s75, s20, s21
    s_and_b32 s20, s17, 7
    s_lshl_b32 s20, s20, 1
    s_and_b32 s21, s18, 1
    s_add_u32 s76, s20, s21
    s_xor_b32 s21, s21, 1
    s_add_u32 s77, s20, s21
    s_cmp_eq_u32 s19, 0
    s_cbranch_scc0 L_skip_35
    s_waitcnt vmcnt(43)
    s_barrier
    s_cmp_lg_u32 s80, 0
    s_cbranch_scc0 L_skip_36
    s_cmp_eq_u32 s80, 1
    s_cbranch_scc0 L_skip_37
    s_lshl_b32 s20, s18, 13
    s_add_u32 s20, s20, 114688
    v_add_u32 v228, s20, v244
    ds_read_b64_tr_b16 v[132:133], v228
    ds_read_b64_tr_b16 v[134:135], v228 offset:1024
    ds_read_b64_tr_b16 v[136:137], v228 offset:64
    ds_read_b64_tr_b16 v[138:139], v228 offset:1088
    ds_read_b64_tr_b16 v[140:141], v228 offset:2048
    ds_read_b64_tr_b16 v[142:143], v228 offset:3072
    ds_read_b64_tr_b16 v[144:145], v228 offset:2112
    ds_read_b64_tr_b16 v[146:147], v228 offset:3136
    ds_read_b64_tr_b16 v[148:149], v228 offset:4096
    ds_read_b64_tr_b16 v[150:151], v228 offset:5120
    ds_read_b64_tr_b16 v[152:153], v228 offset:4160
    ds_read_b64_tr_b16 v[154:155], v228 offset:5184
    ds_read_b64_tr_b16 v[156:157], v228 offset:6144
    ds_read_b64_tr_b16 v[158:159], v228 offset:7168
    ds_read_b64_tr_b16 v[160:161], v228 offset:6208
    ds_read_b64_tr_b16 v[162:163], v228 offset:7232
    s_waitcnt lgkmcnt(14)
    buffer_store_dwordx4 v[132:135], v0, s[4:7], s83 offen sc1
    s_waitcnt lgkmcnt(12)
    buffer_store_dwordx4 v[136:139], v0, s[4:7], s97 offen sc1
    s_waitcnt lgkmcnt(10)
    buffer_store_dwordx4 v[140:143], v0, s[4:7], s83 offen offset:1024 sc1
    s_waitcnt lgkmcnt(8)
    buffer_store_dwordx4 v[144:147], v0, s[4:7], s97 offen offset:1024 sc1
    s_waitcnt lgkmcnt(6)
    buffer_store_dwordx4 v[148:151], v0, s[4:7], s83 offen offset:2048 sc1
    s_waitcnt lgkmcnt(4)
    buffer_store_dwordx4 v[152:155], v0, s[4:7], s97 offen offset:2048 sc1
    s_waitcnt lgkmcnt(2)
    buffer_store_dwordx4 v[156:159], v0, s[4:7], s83 offen offset:3072 sc1
    s_waitcnt lgkmcnt(0)
    buffer_store_dwordx4 v[160:163], v0, s[4:7], s97 offen offset:3072 sc1
L_skip_37:
    s_cmp_eq_u32 s80, 2
    s_cbranch_scc0 L_skip_38
    s_lshl_b32 s20, s18, 13
    s_add_u32 s20, s20, 114688
    v_add_u32 v228, s20, v245
    v_mov_b32 v224, 1065369472
    v_mov_b32 v225, 1065369472
    v_mov_b32 v226, 1065369472
    v_mov_b32 v227, 1065369472
    ds_read_b64_tr_b16 v[132:133], v228
    ds_read_b64_tr_b16 v[134:135], v228 offset:1024
    ds_read_b64_tr_b16 v[136:137], v228 offset:32
    ds_read_b64_tr_b16 v[138:139], v228 offset:1056
    ds_read_b64_tr_b16 v[140:141], v228 offset:64
    ds_read_b64_tr_b16 v[142:143], v228 offset:1088
    ds_read_b64_tr_b16 v[144:145], v228 offset:96
    ds_read_b64_tr_b16 v[146:147], v228 offset:1120
    ds_read_b64_tr_b16 v[148:149], v228 offset:2048
    ds_read_b64_tr_b16 v[150:151], v228 offset:3072
    ds_read_b64_tr_b16 v[152:153], v228 offset:2080
    ds_read_b64_tr_b16 v[154:155], v228 offset:3104
    ds_read_b64_tr_b16 v[156:157], v228 offset:2112
    ds_read_b64_tr_b16 v[158:159], v228 offset:3136
    ds_read_b64_tr_b16 v[160:161], v228 offset:2144
    ds_read_b64_tr_b16 v[162:163], v228 offset:3168
    s_mov_b32 s20, s83
    s_waitcnt lgkmcnt(14)
    buffer_store_dwordx4 v[132:135], v0, s[4:7], s20 offen sc1
    s_add_u32 s20, s20, 32768
    s_waitcnt lgkmcnt(12)
    buffer_store_dwordx4 v[136:139], v0, s[4:7], s20 offen sc1
    s_add_u32 s20, s20, 32768
    s_waitcnt lgkmcnt(10)
    buffer_store_dwordx4 v[140:143], v0, s[4:7], s20 offen sc1
    s_add_u32 s20, s20, 32768
    s_cmp_eq_u32 s98, 0
    s_cbranch_scc0 L_skip_39
    s_waitcnt lgkmcnt(8)
    buffer_store_dwordx4 v[144:147], v0, s[4:7], s20 offen sc1
L_skip_39:
    s_mov_b32 s20, s83
    s_waitcnt lgkmcnt(6)
    buffer_store_dwordx4 v[148:151], v0, s[4:7], s20 offen offset:1024 sc1
    s_add_u32 s20, s20, 32768
    s_waitcnt lgkmcnt(4)
    buffer_store_dwordx4 v[152:155], v0, s[4:7], s20 offen offset:1024 sc1
    s_add_u32 s20, s20, 32768
    s_waitcnt lgkmcnt(2)
    buffer_store_dwordx4 v[156:159], v0, s[4:7], s20 offen offset:1024 sc1
    s_add_u32 s20, s20, 32768
    s_cmp_eq_u32 s98, 0
    s_cbranch_scc0 L_skip_40
    s_waitcnt lgkmcnt(0)
    buffer_store_dwordx4 v[160:163], v0, s[4:7], s20 offen offset:1024 sc1
L_skip_40:
    v_mfma_f32_32x32x16_bf16 v[56:71], v[224:227], v[132:135], 0
    v_mfma_f32_32x32x16_bf16 v[172:187], v[224:227], v[136:139], 0
    v_mfma_f32_32x32x16_bf16 v[192:207], v[224:227], v[140:143], 0
    v_mfma_f32_32x32x16_bf16 v[208:223], v[224:227], v[144:147], 0
    v_mfma_f32_32x32x16_bf16 v[56:71], v[224:227], v[148:151], v[56:71]
    v_mfma_f32_32x32x16_bf16 v[172:187], v[224:227], v[152:155], v[172:187]
    v_mfma_f32_32x32x16_bf16 v[192:207], v[224:227], v[156:159], v[192:207]
    s_waitcnt lgkmcnt(0)
    v_mfma_f32_32x32x16_bf16 v[208:223], v[224:227], v[160:163], v[208:223]
    s_nop 8
    v_cndmask_b32 v232, v56, v172, s[62:63]
    s_nop 1
    v_cndmask_b32 v233, v192, v208, s[62:63]
    s_lshl_b32 s20, s18, 8
    s_add_u32 s20, s20, 102400
    v_lshlrev_b32 v229, 2, v3
    v_add_u32 v230, s20, v229
    ds_write_b32 v230, v232
    ds_write_b32 v230, v233 offset:1024
    s_waitcnt lgkmcnt(0)
    s_barrier
    s_cmp_lt_u32 s18, 2
    s_cbranch_scc0 L_skip_41
    s_lshl_b32 s20, s18, 10
    s_add_u32 s20, s20, 102400
    v_add_u32 v230, s20, v229
    ds_read_b32 v40, v230
    ds_read_b32 v41, v230 offset:256
    ds_read_b32 v42, v230 offset:512
    ds_read_b32 v43, v230 offset:768
    s_waitcnt lgkmcnt(2)
    v_add_f32 v40, v40, v41
    s_waitcnt lgkmcnt(0)
    v_add_f32 v42, v42, v43
    v_add_f32 v40, v40, v42
    v_lshrrev_b32 v229, 5, v3
    v_lshlrev_b32 v229, 9, v229
    v_lshrrev_b32 v230, 2, v7
    v_add_u32 v229, v229, v230
    s_mul_i32 s20, s17, 7
    s_lshl_b32 s21, s98, 2
    s_add_u32 s20, s20, s21
    s_lshl_b32 s21, s18, 1
    s_add_u32 s20, s20, s21
    s_lshl_b32 s20, s20, 2
    s_add_u32 s20, s20, s99
    s_lshl_b32 s20, s20, 7
    s_add_u32 s20, s20, 7864320
    s_and_b32 s21, s98, s18
    s_cmp_eq_u32 s21, 1
    s_cselect_b32 s22, 0, -1
    s_mov_b32 exec_lo, -1
    s_mov_b32 exec_hi, s22
    buffer_store_dword v40, v229, s[4:7], s20 offen sc1
    s_mov_b64 exec, -1
L_skip_41:
L_skip_38:
L_skip_36:
L_skip_35:
    s_waitcnt vmcnt(27)
    s_waitcnt lgkmcnt(0)
    s_barrier
    ds_read_b128 v[72:75], v0 offset:32768
    ds_read_b128 v[76:79], v1
    ds_read_b128 v[80:83], v0 offset:33792
    ds_read_b128 v[84:87], v1 offset:1024
    ds_read_b128 v[88:91], v0 offset:34816
    ds_read_b128 v[92:95], v1 offset:2048
    s_waitcnt vmcnt(15) lgkmcnt(4)
    v_mfma_f32_32x32x16_bf16 v[24:39], a[0:3], v[72:75], 0
    ds_read_b128 v[236:239], v0 offset:35840
    s_add_u32 s79, s79, 4096
    buffer_load_dwordx4 a[48:51], v0, s[4:7], s79 offen sc1
    v_mfma_f32_32x32x16_bf16 v[40:55], a[0:3], v[76:79], 0
    ds_read_b128 v[240:243], v1 offset:3072
    s_waitcnt vmcnt(15) lgkmcnt(4)
    v_mfma_f32_32x32x16_bf16 v[24:39], a[4:7], v[80:83], v[24:39]
    ds_read_b128 v[72:75], v0 offset:36864
    buffer_load_dwordx4 a[52:55], v0, s[4:7], s79 offen offset:1024 sc1
    v_mfma_f32_32x32x16_bf16 v[40:55], a[4:7], v[84:87], v[40:55]
    ds_read_b128 v[76:79], v1 offset:4096
    s_waitcnt vmcnt(11) lgkmcnt(4)
    v_mfma_f32_32x32x16_bf16 v[24:39], a[8:11], v[88:91], v[24:39]
    ds_read_b128 v[80:83], v0 offset:37888
    buffer_load_dwordx4 a[56:59], v0, s[4:7], s79 offen offset:2048 sc1
    v_mfma_f32_32x32x16_bf16 v[40:55], a[8:11], v[92:95], v[40:55]
    ds_read_b128 v[84:87], v1 offset:5120
    s_waitcnt vmcnt(11) lgkmcnt(4)
    v_mfma_f32_32x32x16_bf16 v[24:39], a[12:15], v[236:239], v[24:39]
    ds_read_b128 v[88:91], v0 offset:38912
    buffer_load_dwordx4 a[60:63], v0, s[4:7], s79 offen offset:3072 sc1
    v_mfma_f32_32x32x16_bf16 v[40:55], a[12:15], v[240:243], v[40:55]
    ds_read_b128 v[92:95], v1 offset:6144
    s_waitcnt vmcnt(11) lgkmcnt(4)
    v_mfma_f32_32x32x16_bf16 v[24:39], a[16:19], v[72:75], v[24:39]
    ds_read_b128 v[236:239], v0 offset:39936
    s_add_u32 s79, s79, 4096
    buffer_load_dwordx4 a[64:67], v0, s[4:7], s79 offen sc1
    v_pk_add_f32 v[8:9], v[8:9], v[12:13]
    v_mfma_f32_32x32x16_bf16 v[40:55], a[16:19], v[76:79], v[40:55]
    ds_read_b128 v[240:243], v1 offset:7168
    v_pk_add_f32 v[10:11], v[10:11], v[14:15]
    v_pk_add_f32 v[8:9], v[8:9], v[16:17]
    s_waitcnt vmcnt(11) lgkmcnt(4)
    v_mfma_f32_32x32x16_bf16 v[24:39], a[20:23], v[80:83], v[24:39]
    ds_read_b128 v[72:75], v0 offset:40960
    buffer_load_dwordx4 a[68:71], v0, s[4:7], s79 offen offset:1024 sc1
    v_pk_add_f32 v[10:11], v[10:11], v[18:19]
    v_pk_add_f32 v[8:9], v[8:9], v[20:21]
    v_mfma_f32_32x32x16_bf16 v[40:55], a[20:23], v[84:87], v[40:55]
    ds_read_b128 v[76:79], v1 offset:8192
    v_pk_add_f32 v[10:11], v[10:11], v[22:23]
    ds_swizzle_b32 v12, v8 offset:0x101f
    s_waitcnt vmcnt(11) lgkmcnt(5)
    v_mfma_f32_32x32x16_bf16 v[24:39], a[24:27], v[88:91], v[24:39]
    ds_read_b128 v[80:83], v0 offset:41984
    buffer_load_dwordx4 a[72:75], v0, s[4:7], s79 offen offset:2048 sc1
    ds_swizzle_b32 v13, v9 offset:0x101f
    ds_swizzle_b32 v14, v10 offset:0x101f
    v_mfma_f32_32x32x16_bf16 v[40:55], a[24:27], v[92:95], v[40:55]
    ds_read_b128 v[84:87], v1 offset:9216
    ds_swizzle_b32 v15, v11 offset:0x101f
    v_lshrrev_b32 v16, 1, v3
    s_waitcnt vmcnt(11) lgkmcnt(8)
    v_mfma_f32_32x32x16_bf16 v[24:39], a[28:31], v[236:239], v[24:39]
    ds_read_b128 v[88:91], v0 offset:43008
    buffer_load_dwordx4 a[76:79], v0, s[4:7], s79 offen offset:3072 sc1
    v_and_b32 v16, 3, v16
    v_and_b32 v17, 56, v3
    v_mfma_f32_32x32x16_bf16 v[40:55], a[28:31], v[240:243], v[40:55]
    ds_read_b128 v[92:95], v1 offset:10240
    v_or_b32 v16, v16, v17
    v_lshlrev_b32 v16, 2, v16
    s_waitcnt vmcnt(11) lgkmcnt(8)
    v_mfma_f32_32x32x16_bf16 v[24:39], a[32:35], v[72:75], v[24:39]
    ds_read_b128 v[236:239], v0 offset:44032
    s_add_u32 s79, s79, 4096
    buffer_load_dwordx4 a[80:83], v0, s[4:7], s79 offen sc1
    v_and_b32 v17, 1, v3
    v_cmp_eq_u32 vcc, 1, v17
    v_mfma_f32_32x32x16_bf16 v[40:55], a[32:35], v[76:79], v[40:55]
    ds_read_b128 v[240:243], v1 offset:11264
    s_waitcnt lgkmcnt(7)
    v_pk_add_f32 v[8:9], v[8:9], v[12:13]
    s_waitcnt lgkmcnt(4)
    v_pk_add_f32 v[10:11], v[10:11], v[14:15]
    s_waitcnt vmcnt(11)
    v_mfma_f32_32x32x16_bf16 v[24:39], a[36:39], v[80:83], v[24:39]
    ds_read_b128 v[72:75], v0 offset:45056
    buffer_load_dwordx4 a[84:87], v0, s[4:7], s79 offen offset:1024 sc1
    ds_bpermute_b32 v12, v16, v8
    ds_bpermute_b32 v13, v16, v9
    v_mfma_f32_32x32x16_bf16 v[40:55], a[36:39], v[84:87], v[40:55]
    ds_read_b128 v[76:79], v1 offset:12288
    ds_bpermute_b32 v14, v16, v10
    ds_bpermute_b32 v15, v16, v11
    s_waitcnt vmcnt(11) lgkmcnt(8)
    v_mfma_f32_32x32x16_bf16 v[24:39], a[40:43], v[88:91], v[24:39]
    ds_read_b128 v[80:83], v0 offset:46080
    buffer_load_dwordx4 a[88:91], v0, s[4:7], s79 offen offset:2048 sc1
    s_waitcnt lgkmcnt(2)
    v_cndmask_b32 v166, v12, v14, vcc
    s_waitcnt lgkmcnt(1)
    v_cndmask_b32 v167, v13, v15, vcc
    v_mfma_f32_32x32x16_bf16 v[40:55], a[40:43], v[92:95], v[40:55]
    ds_read_b128 v[84:87], v1 offset:13312
    v_mov_b32 v168, v166
    v_mov_b32 v169, v167
    s_waitcnt vmcnt(11)
    v_mfma_f32_32x32x16_bf16 v[24:39], a[44:47], v[236:239], v[24:39]
    ds_read_b128 v[88:91], v0 offset:47104
    buffer_load_dwordx4 a[92:95], v0, s[4:7], s79 offen offset:3072 sc1
    v_permlane32_swap_b32 v166, v168
    v_permlane32_swap_b32 v167, v169
    v_mfma_f32_32x32x16_bf16 v[40:55], a[44:47], v[240:243], v[40:55]
    ds_read_b128 v[92:95], v1 offset:14336
    v_add_f32 v166, v166, v168
    v_add_f32 v167, v167, v169
    s_waitcnt vmcnt(11)
    v_mfma_f32_32x32x16_bf16 v[24:39], a[48:51], v[72:75], v[24:39]
    ds_read_b128 v[236:239], v0 offset:48128
    s_add_u32 s79, s79, 4096
    buffer_load_dwordx4 a[96:99], v0, s[4:7], s79 offen sc1
    v_mul_f32 v164, 0.001953125, v166
    v_mul_f32 v168, v164, v164
    v_mfma_f32_32x32x16_bf16 v[40:55], a[48:51], v[76:79], v[40:55]
    ds_read_b128 v[240:243], v1 offset:15360
    v_mul_f32 v167, 0.001953125, v167
    v_sub_f32 v167, v167, v168
    s_waitcnt vmcnt(11) lgkmcnt(4)
    v_mfma_f32_32x32x16_bf16 v[24:39], a[52:55], v[80:83], v[24:39]
    ds_read_b128 v[72:75], v0 offset:49152
    buffer_load_dwordx4 a[100:103], v0, s[4:7], s79 offen offset:1024 sc1
    v_max_f32 v167, 0, v167
    v_add_f32 v168, 1e-05, v167
    v_mfma_f32_32x32x16_bf16 v[40:55], a[52:55], v[84:87], v[40:55]
    ds_read_b128 v[76:79], v1 offset:16384
    v_rsq_f32 v232, v168
    v_sub_f32 v166, 0, v164
    s_waitcnt vmcnt(11) lgkmcnt(4)
    v_mfma_f32_32x32x16_bf16 v[24:39], a[56:59], v[88:91], v[24:39]
    ds_read_b128 v[80:83], v0 offset:50176
    buffer_load_dwordx4 a[104:107], v0, s[4:7], s79 offen offset:2048 sc1
    v_cvt_pk_bf16_f32 v96, v166, v166
    v_lshlrev_b32 v167, 16, v96
    v_mfma_f32_32x32x16_bf16 v[40:55], a[56:59], v[92:95], v[40:55]
    ds_read_b128 v[84:87], v1 offset:17408
    v_sub_f32 v167, v166, v167
    v_mov_b32 v98, 0
    s_waitcnt vmcnt(11) lgkmcnt(4)
    v_mfma_f32_32x32x16_bf16 v[24:39], a[60:63], v[236:239], v[24:39]
    ds_read_b128 v[88:91], v0 offset:51200
    buffer_load_dwordx4 a[108:111], v0, s[4:7], s79 offen offset:3072 sc1
    v_mov_b32 v99, 0
    v_cvt_pk_bf16_f32 v97, v167, v98
    v_mfma_f32_32x32x16_bf16 v[40:55], a[60:63], v[240:243], v[40:55]
    ds_read_b128 v[92:95], v1 offset:18432
    v_cndmask_b32 v96, v96, v98, s[62:63]
    v_cndmask_b32 v97, v97, v98, s[62:63]
    s_waitcnt vmcnt(11) lgkmcnt(4)
    v_mfma_f32_32x32x16_bf16 v[24:39], a[64:67], v[72:75], v[24:39]
    ds_read_b128 v[236:239], v0 offset:52224
    s_add_u32 s79, s79, 4096
    buffer_load_dwordx4 a[112:115], v0, s[4:7], s79 offen sc1
    s_lshl_b32 s20, s18, 7
    s_add_u32 s20, s20, 151552
    v_mfma_f32_32x32x16_bf16 v[40:55], a[64:67], v[76:79], v[40:55]
    ds_read_b128 v[240:243], v1 offset:19456
    v_lshrrev_b32 v166, 2, v7
    v_add_u32 v166, s20, v166
    s_waitcnt vmcnt(11) lgkmcnt(4)
    v_mfma_f32_32x32x16_bf16 v[24:39], a[68:71], v[80:83], v[24:39]
    ds_read_b128 v[72:75], v0 offset:53248
    buffer_load_dwordx4 a[116:119], v0, s[4:7], s79 offen offset:1024 sc1
    ds_write_b32 v166, v232
    v_lshrrev_b32 v167, 5, v3
    v_mfma_f32_32x32x16_bf16 v[40:55], a[68:71], v[84:87], v[40:55]
    ds_read_b128 v[76:79], v1 offset:20480
    v_lshlrev_b32 v167, 4, v167
    v_add_u32 v167, s20, v167
    s_waitcnt vmcnt(11) lgkmcnt(5)
    v_mfma_f32_32x32x16_bf16 v[24:39], a[72:75], v[88:91], v[24:39]
    ds_read_b128 v[80:83], v0 offset:54272
    buffer_load_dwordx4 a[120:123], v0, s[4:7], s79 offen offset:2048 sc1
    ds_read_b128 v[100:103], v167
    ds_read_b128 v[104:107], v167 offset:32
    v_mfma_f32_32x32x16_bf16 v[40:55], a[72:75], v[92:95], v[40:55]
    ds_read_b128 v[84:87], v1 offset:21504
    ds_read_b128 v[108:111], v167 offset:64
    ds_read_b128 v[112:115], v167 offset:96
    s_waitcnt vmcnt(11) lgkmcnt(9)
    v_mfma_f32_32x32x16_bf16 v[24:39], a[76:79], v[236:239], v[24:39]
    ds_read_b128 v[88:91], v0 offset:55296
    buffer_load_dwordx4 a[124:127], v0, s[4:7], s79 offen offset:3072 sc1
    v_mul_f32 v233, 1.4426950408889634, v232
    v_mov_b32 v170, 1e-06
    v_mfma_f32_32x32x16_bf16 v[40:55], a[76:79], v[240:243], v[40:55]
    ds_read_b128 v[92:95], v1 offset:22528
    v_mov_b32 v171, 1e-06
    v_mov_b32 v188, 1065369472
    s_waitcnt vmcnt(11) lgkmcnt(8)
    v_mfma_f32_32x32x16_bf16 v[24:39], a[80:83], v[72:75], v[24:39]
    ds_read_b128 v[236:239], v0 offset:56320
    v_mov_b32 v189, 1065369472
    v_mov_b32 v190, 1065369472
    v_mfma_f32_32x32x16_bf16 v[40:55], a[80:83], v[76:79], v[40:55]
    ds_read_b128 v[240:243], v1 offset:23552
    v_mov_b32 v191, 1065369472
    s_waitcnt lgkmcnt(8)
    v_mul_f32 v116, 1.4426950408889634, v100
    s_waitcnt vmcnt(10) lgkmcnt(6)
    v_mfma_f32_32x32x16_bf16 v[24:39], a[84:87], v[80:83], v[24:39]
    ds_read_b128 v[72:75], v0 offset:57344
    v_mul_f32 v117, 1.4426950408889634, v101
    v_mul_f32 v118, 1.4426950408889634, v102
    v_mfma_f32_32x32x16_bf16 v[40:55], a[84:87], v[84:87], v[40:55]
    ds_read_b128 v[76:79], v1 offset:24576
    v_mul_f32 v119, 1.4426950408889634, v103
    v_mul_f32 v120, 1.4426950408889634, v104
    s_waitcnt vmcnt(9) lgkmcnt(4)
    v_mfma_f32_32x32x16_bf16 v[24:39], a[88:91], v[88:91], v[24:39]
    ds_read_b128 v[80:83], v0 offset:58368
    v_mul_f32 v121, 1.4426950408889634, v105
    v_mul_f32 v122, 1.4426950408889634, v106
    v_mfma_f32_32x32x16_bf16 v[40:55], a[88:91], v[92:95], v[40:55]
    ds_read_b128 v[84:87], v1 offset:25600
    v_mul_f32 v123, 1.4426950408889634, v107
    v_mul_f32 v124, 1.4426950408889634, v108
    s_waitcnt vmcnt(8) lgkmcnt(4)
    v_mfma_f32_32x32x16_bf16 v[24:39], a[92:95], v[236:239], v[24:39]
    ds_read_b128 v[88:91], v0 offset:59392
    v_mul_f32 v125, 1.4426950408889634, v109
    v_mul_f32 v126, 1.4426950408889634, v110
    v_mfma_f32_32x32x16_bf16 v[40:55], a[92:95], v[240:243], v[40:55]
    ds_read_b128 v[92:95], v1 offset:26624
    v_mul_f32 v127, 1.4426950408889634, v111
    v_mul_f32 v128, 1.4426950408889634, v112
    s_waitcnt vmcnt(7) lgkmcnt(4)
    v_mfma_f32_32x32x16_bf16 v[24:39], a[96:99], v[72:75], v[24:39]
    ds_read_b128 v[236:239], v0 offset:60416
    v_mul_f32 v129, 1.4426950408889634, v113
    v_mul_f32 v130, 1.4426950408889634, v114
    v_mfma_f32_32x32x16_bf16 v[40:55], a[96:99], v[76:79], v[40:55]
    ds_read_b128 v[240:243], v1 offset:27648
    v_mul_f32 v131, 1.4426950408889634, v115
    s_waitcnt vmcnt(6) lgkmcnt(4)
    v_mfma_f32_32x32x16_bf16 v[24:39], a[100:103], v[80:83], v[24:39]
    ds_read_b128 v[72:75], v0 offset:61440
    v_mfma_f32_32x32x16_bf16 v[40:55], a[100:103], v[84:87], v[40:55]
    ds_read_b128 v[76:79], v1 offset:28672
    s_waitcnt vmcnt(5) lgkmcnt(4)
    v_mfma_f32_32x32x16_bf16 v[24:39], a[104:107], v[88:91], v[24:39]
    ds_read_b128 v[80:83], v0 offset:62464
    v_mfma_f32_32x32x16_bf16 v[40:55], a[104:107], v[92:95], v[40:55]
    ds_read_b128 v[84:87], v1 offset:29696
    s_waitcnt vmcnt(4) lgkmcnt(4)
    v_mfma_f32_32x32x16_bf16 v[24:39], a[108:111], v[236:239], v[24:39]
    ds_read_b128 v[88:91], v0 offset:63488
    v_mfma_f32_32x32x16_bf16 v[40:55], a[108:111], v[240:243], v[40:55]
    ds_read_b128 v[92:95], v1 offset:30720
    s_waitcnt vmcnt(3) lgkmcnt(4)
    v_mfma_f32_32x32x16_bf16 v[24:39], a[112:115], v[72:75], v[24:39]
    ds_read_b128 v[236:239], v0 offset:64512
    v_mfma_f32_32x32x16_bf16 v[40:55], a[112:115], v[76:79], v[40:55]
    ds_read_b128 v[240:243], v1 offset:31744
    s_waitcnt vmcnt(2) lgkmcnt(4)
    v_mfma_f32_32x32x16_bf16 v[24:39], a[116:119], v[80:83], v[24:39]
    ds_read_b128 v[72:75], v2 offset:17408
    v_mfma_f32_32x32x16_bf16 v[40:55], a[116:119], v[84:87], v[40:55]
    ds_read_b128 v[76:79], v2 offset:18432
    s_waitcnt vmcnt(1) lgkmcnt(4)
    v_mfma_f32_32x32x16_bf16 v[24:39], a[120:123], v[88:91], v[24:39]
    v_mfma_f32_32x32x16_bf16 v[40:55], a[120:123], v[92:95], v[40:55]
    s_waitcnt vmcnt(0) lgkmcnt(2)
    v_mfma_f32_32x32x16_bf16 v[24:39], a[124:127], v[236:239], v[24:39]
    v_mfma_f32_32x32x16_bf16 v[40:55], a[124:127], v[240:243], v[40:55]
    s_waitcnt lgkmcnt(0)
    v_mfma_f32_32x32x16_bf16 v[24:39], v[96:99], v[72:75], v[24:39]
    v_mfma_f32_32x32x16_bf16 v[40:55], v[96:99], v[76:79], v[40:55]
    s_nop 10
    v_pk_mul_f32 v[132:133], v[24:25], v[116:117]
    v_pk_mul_f32 v[134:135], v[26:27], v[118:119]
    v_pk_mul_f32 v[136:137], v[28:29], v[120:121]
    v_pk_mul_f32 v[138:139], v[30:31], v[122:123]
    v_pk_mul_f32 v[140:141], v[32:33], v[124:125]
    v_pk_mul_f32 v[142:143], v[34:35], v[126:127]
    v_pk_mul_f32 v[144:145], v[36:37], v[128:129]
    v_pk_mul_f32 v[146:147], v[38:39], v[130:131]
    v_min_f32 v132, 0, v132
    v_min_f32 v133, 0, v133
    s_and_b32 s26, s18, 1
    s_xor_b32 s26, s26, 0
    s_and_b32 s27, s17, 7
    s_lshl_b32 s27, s27, 1
    s_add_u32 s27, s27, s26
    s_lshl_b32 s27, s27, 15
    s_lshl_b32 s26, s18, 13
    s_add_u32 s27, s27, s26
    s_add_u32 s27, s27, 3145728
    buffer_load_dwordx4 a[128:131], v0, s[4:7], s27 offen sc1
    v_min_f32 v134, 0, v134
    v_min_f32 v135, 0, v135
    v_min_f32 v136, 0, v136
    v_min_f32 v137, 0, v137
    v_min_f32 v138, 0, v138
    v_min_f32 v139, 0, v139
    v_min_f32 v140, 0, v140
    v_min_f32 v141, 0, v141
    v_min_f32 v142, 0, v142
    v_min_f32 v143, 0, v143
    buffer_load_dwordx4 a[132:135], v0, s[4:7], s27 offen offset:1024 sc1
    v_min_f32 v144, 0, v144
    v_min_f32 v145, 0, v145
    v_min_f32 v146, 0, v146
    v_min_f32 v147, 0, v147
    v_exp_f32 v132, v132
    v_exp_f32 v133, v133
    v_exp_f32 v134, v134
    v_exp_f32 v135, v135
    v_exp_f32 v136, v136
    v_exp_f32 v137, v137
    buffer_load_dwordx4 a[136:139], v0, s[4:7], s27 offen offset:2048 sc1
    v_exp_f32 v138, v138
    v_exp_f32 v139, v139
    v_exp_f32 v140, v140
    v_exp_f32 v141, v141
    v_exp_f32 v142, v142
    v_exp_f32 v143, v143
    v_exp_f32 v144, v144
    v_exp_f32 v145, v145
    v_exp_f32 v146, v146
    v_exp_f32 v147, v147
    buffer_load_dwordx4 a[140:143], v0, s[4:7], s27 offen offset:3072 sc1
    v_pk_fma_f32 v[148:149], v[24:25], v[100:101], v[170:171]
    v_pk_fma_f32 v[150:151], v[26:27], v[102:103], v[170:171]
    v_pk_fma_f32 v[152:153], v[28:29], v[104:105], v[170:171]
    v_pk_fma_f32 v[154:155], v[30:31], v[106:107], v[170:171]
    v_pk_fma_f32 v[156:157], v[32:33], v[108:109], v[170:171]
    v_pk_fma_f32 v[158:159], v[34:35], v[110:111], v[170:171]
    v_pk_fma_f32 v[160:161], v[36:37], v[112:113], v[170:171]
    v_pk_fma_f32 v[162:163], v[38:39], v[114:115], v[170:171]
    v_max_f32 v148, v170, v148
    v_max_f32 v149, v170, v149
    s_add_u32 s27, s27, 4096
    buffer_load_dwordx4 a[144:147], v0, s[4:7], s27 offen sc1
    v_max_f32 v150, v170, v150
    v_max_f32 v151, v170, v151
    v_max_f32 v152, v170, v152
    v_max_f32 v153, v170, v153
    v_max_f32 v154, v170, v154
    v_max_f32 v155, v170, v155
    v_max_f32 v156, v170, v156
    v_max_f32 v157, v170, v157
    v_max_f32 v158, v170, v158
    v_max_f32 v159, v170, v159
    buffer_load_dwordx4 a[148:151], v0, s[4:7], s27 offen offset:1024 sc1
    v_max_f32 v160, v170, v160
    v_max_f32 v161, v170, v161
    v_max_f32 v162, v170, v162
    v_max_f32 v163, v170, v163
    v_pk_add_f32 v[148:149], v[148:149], v[132:133]
    v_pk_add_f32 v[150:151], v[150:151], v[134:135]
    v_pk_add_f32 v[152:153], v[152:153], v[136:137]
    v_pk_add_f32 v[154:155], v[154:155], v[138:139]
    v_pk_add_f32 v[156:157], v[156:157], v[140:141]
    v_pk_add_f32 v[158:159], v[158:159], v[142:143]
    buffer_load_dwordx4 a[152:155], v0, s[4:7], s27 offen offset:2048 sc1
    v_pk_add_f32 v[160:161], v[160:161], v[144:145]
    v_pk_add_f32 v[162:163], v[162:163], v[146:147]
    v_cvt_pk_bf16_f32 v172, v148, v149
    v_cvt_pk_bf16_f32 v173, v150, v151
    v_cvt_pk_bf16_f32 v174, v152, v153
    v_cvt_pk_bf16_f32 v175, v154, v155
    v_cvt_pk_bf16_f32 v176, v156, v157
    v_cvt_pk_bf16_f32 v177, v158, v159
    v_cvt_pk_bf16_f32 v178, v160, v161
    v_cvt_pk_bf16_f32 v179, v162, v163
    buffer_load_dwordx4 a[156:159], v0, s[4:7], s27 offen offset:3072 sc1
    v_pk_mul_f32 v[40:41], v[40:41], v[100:101]
    v_pk_mul_f32 v[42:43], v[42:43], v[102:103]
    v_pk_mul_f32 v[44:45], v[44:45], v[104:105]
    v_pk_mul_f32 v[46:47], v[46:47], v[106:107]
    v_pk_mul_f32 v[48:49], v[48:49], v[108:109]
    v_pk_mul_f32 v[50:51], v[50:51], v[110:111]
    v_pk_mul_f32 v[52:53], v[52:53], v[112:113]
    v_pk_mul_f32 v[54:55], v[54:55], v[114:115]
    v_mfma_f32_32x32x16_bf16 v[208:223], v[188:191], v[172:175], 0
    v_cvt_pk_bf16_f32 v180, v40, v41
    s_and_b32 s26, s18, 1
    s_xor_b32 s26, s26, 1
    s_and_b32 s27, s17, 7
    s_lshl_b32 s27, s27, 1
    s_add_u32 s27, s27, s26
    s_lshl_b32 s27, s27, 15
    s_lshl_b32 s26, s18, 13
    s_add_u32 s27, s27, s26
    s_add_u32 s27, s27, 3145728
    buffer_load_dwordx4 a[160:163], v0, s[4:7], s27 offen sc1
    v_cvt_pk_bf16_f32 v181, v42, v43
    v_cvt_pk_bf16_f32 v182, v44, v45
    v_cvt_pk_bf16_f32 v183, v46, v47
    v_cvt_pk_bf16_f32 v184, v48, v49
    v_cvt_pk_bf16_f32 v185, v50, v51
    v_cvt_pk_bf16_f32 v186, v52, v53
    v_cvt_pk_bf16_f32 v187, v54, v55
    v_mfma_f32_32x32x16_bf16 v[208:223], v[188:191], v[176:179], v[208:223]
    v_mfma_f32_32x32x16_bf16 v[192:207], v[172:175], v[180:183], 0
    v_mfma_f32_32x32x16_bf16 v[192:207], v[176:179], v[184:187], v[192:207]
    buffer_load_dwordx4 a[164:167], v0, s[4:7], s27 offen offset:1024 sc1
    s_mul_i32 s20, s18, 2304
    s_add_u32 s20, s20, 102400
    v_add_u32 v166, s20, v0
    v_lshrrev_b32 v167, 2, v7
    v_add_u32 v167, s20, v167
    s_lshl_b32 s66, s17, 4
    s_add_u32 s66, s66, s16
    s_lshl_b32 s66, s66, 12
    s_lshl_b32 s20, s19, 20
    s_add_u32 s66, s66, s20
    buffer_load_dwordx4 a[168:171], v0, s[4:7], s27 offen offset:2048 sc1
    s_add_u32 s66, s66, 24117248
    s_mul_i32 s58, s19, 28672
    s_lshl_b32 s31, s17, 8
    s_add_u32 s58, s58, s31
    s_add_u32 s58, s58, 8192
    ds_write_b32 v167, v208 offset:2048
    v_cndmask_b32 v132, v192, v200, s[60:61]
    v_cndmask_b32 v133, v193, v201, s[60:61]
    v_cndmask_b32 v134, v194, v202, s[60:61]
    v_cndmask_b32 v135, v195, v203, s[60:61]
    buffer_load_dwordx4 a[172:175], v0, s[4:7], s27 offen offset:3072 sc1
    v_cndmask_b32 v136, v196, v204, s[60:61]
    v_cndmask_b32 v137, v197, v205, s[60:61]
    v_cndmask_b32 v138, v198, v206, s[60:61]
    v_cndmask_b32 v139, v199, v207, s[60:61]
    ds_write_b128 v166, v[132:135]
    ds_write_b128 v166, v[136:139] offset:1024
    s_waitcnt lgkmcnt(0)
    s_barrier
    s_cmp_lt_u32 s18, 2
    s_cbranch_scc0 L_skip_42
    s_lshl_b32 s20, s18, 10
    s_add_u32 s21, s20, 102400
    v_add_u32 v166, s21, v0
    ds_read_b128 v[132:135], v166
    ds_read_b128 v[136:139], v166 offset:2304
    ds_read_b128 v[140:143], v166 offset:4608
    ds_read_b128 v[144:147], v166 offset:6912
    s_waitcnt lgkmcnt(2)
    v_pk_add_f32 v[132:133], v[132:133], v[136:137]
    v_pk_add_f32 v[134:135], v[134:135], v[138:139]
    s_waitcnt lgkmcnt(0)
    v_pk_add_f32 v[140:141], v[140:141], v[144:145]
    v_pk_add_f32 v[142:143], v[142:143], v[146:147]
    v_pk_add_f32 v[132:133], v[132:133], v[140:141]
    v_pk_add_f32 v[134:135], v[134:135], v[142:143]
    s_add_u32 s21, s66, s20
    buffer_store_dwordx4 v[132:135], v0, s[4:7], s21 offen sc1
L_skip_42:
    s_cmp_eq_u32 s18, 2
    s_cbranch_scc0 L_skip_43
    v_lshrrev_b32 v167, 2, v7
    v_add_u32 v166, 102400, v167
    ds_read_b32 v132, v166 offset:2048
    ds_read_b32 v133, v166 offset:4352
    ds_read_b32 v134, v166 offset:6656
    ds_read_b32 v135, v166 offset:8960
    s_waitcnt lgkmcnt(2)
    v_add_f32 v132, v132, v133
    s_waitcnt lgkmcnt(0)
    v_add_f32 v134, v134, v135
    v_add_f32 v132, v132, v134
    buffer_store_dword v132, v167, s[4:7], s66 offen offset:2048 sc1
L_skip_43:
    ds_read_b128 v[72:75], v0
    ds_read_b128 v[76:79], v0 offset:1024
    ds_read_b128 v[80:83], v0 offset:2048
    ds_read_b128 v[84:87], v0 offset:3072
    ds_read_b128 v[88:91], v0 offset:4096
    ds_read_b128 v[92:95], v0 offset:5120
    s_waitcnt lgkmcnt(4)
    v_mfma_f32_32x32x16_bf16 v[56:71], v[72:75], a[0:3], 0
    ds_read_b128 v[236:239], v0 offset:6144
    v_mfma_f32_32x32x16_bf16 v[56:71], v[76:79], a[4:7], v[56:71]
    ds_read_b128 v[240:243], v0 offset:7168
    s_add_u32 s27, s27, 4096
    buffer_load_dwordx4 a[176:179], v0, s[4:7], s27 offen sc1
    s_waitcnt lgkmcnt(4)
    v_mfma_f32_32x32x16_bf16 v[56:71], v[80:83], a[8:11], v[56:71]
    ds_read_b128 v[72:75], v0 offset:8192
    v_mfma_f32_32x32x16_bf16 v[56:71], v[84:87], a[12:15], v[56:71]
    ds_read_b128 v[76:79], v0 offset:9216
    buffer_load_dwordx4 a[180:183], v0, s[4:7], s27 offen offset:1024 sc1
    s_waitcnt lgkmcnt(4)
    v_mfma_f32_32x32x16_bf16 v[56:71], v[88:91], a[16:19], v[56:71]
    ds_read_b128 v[80:83], v0 offset:10240
    v_mfma_f32_32x32x16_bf16 v[56:71], v[92:95], a[20:23], v[56:71]
    ds_read_b128 v[84:87], v0 offset:11264
    buffer_load_dwordx4 a[184:187], v0, s[4:7], s27 offen offset:2048 sc1
    s_waitcnt lgkmcnt(4)
    v_mfma_f32_32x32x16_bf16 v[56:71], v[236:239], a[24:27], v[56:71]
    ds_read_b128 v[88:91], v0 offset:12288
    v_mfma_f32_32x32x16_bf16 v[56:71], v[240:243], a[28:31], v[56:71]
    ds_read_b128 v[92:95], v0 offset:13312
    buffer_load_dwordx4 a[188:191], v0, s[4:7], s27 offen offset:3072 sc1
    s_waitcnt lgkmcnt(4)
    v_mfma_f32_32x32x16_bf16 v[56:71], v[72:75], a[32:35], v[56:71]
    ds_read_b128 v[236:239], v0 offset:14336
    v_mfma_f32_32x32x16_bf16 v[56:71], v[76:79], a[36:39], v[56:71]
    ds_read_b128 v[240:243], v0 offset:15360
    s_waitcnt lgkmcnt(4)
    v_mfma_f32_32x32x16_bf16 v[56:71], v[80:83], a[40:43], v[56:71]
    ds_read_b128 v[72:75], v0 offset:16384
    v_mfma_f32_32x32x16_bf16 v[56:71], v[84:87], a[44:47], v[56:71]
    ds_read_b128 v[76:79], v0 offset:17408
    s_waitcnt lgkmcnt(4)
    v_mfma_f32_32x32x16_bf16 v[56:71], v[88:91], a[48:51], v[56:71]
    ds_read_b128 v[80:83], v0 offset:18432
    v_mfma_f32_32x32x16_bf16 v[56:71], v[92:95], a[52:55], v[56:71]
    ds_read_b128 v[84:87], v0 offset:19456
    s_waitcnt lgkmcnt(4)
    v_mfma_f32_32x32x16_bf16 v[56:71], v[236:239], a[56:59], v[56:71]
    ds_read_b128 v[88:91], v0 offset:20480
    s_waitcnt vmcnt(4)
    s_barrier
    s_cmp_eq_u32 s18, 0
    s_cbranch_scc0 L_skip_44
    s_mov_b64 exec, 1
    buffer_atomic_add v4, off, s[4:7], s58
    s_mov_b64 exec, -1
L_skip_44:
    v_mfma_f32_32x32x16_bf16 v[56:71], v[240:243], a[60:63], v[56:71]
    ds_read_b128 v[92:95], v0 offset:21504
    s_waitcnt lgkmcnt(4)
    v_mfma_f32_32x32x16_bf16 v[56:71], v[72:75], a[64:67], v[56:71]
    ds_read_b128 v[236:239], v0 offset:22528
    v_mfma_f32_32x32x16_bf16 v[56:71], v[76:79], a[68:71], v[56:71]
    ds_read_b128 v[240:243], v0 offset:23552
    s_waitcnt lgkmcnt(4)
    v_mfma_f32_32x32x16_bf16 v[56:71], v[80:83], a[72:75], v[56:71]
    ds_read_b128 v[72:75], v0 offset:24576
    v_mfma_f32_32x32x16_bf16 v[56:71], v[84:87], a[76:79], v[56:71]
    ds_read_b128 v[76:79], v0 offset:25600
    s_waitcnt lgkmcnt(4)
    v_mfma_f32_32x32x16_bf16 v[56:71], v[88:91], a[80:83], v[56:71]
    ds_read_b128 v[80:83], v0 offset:26624
    v_mfma_f32_32x32x16_bf16 v[56:71], v[92:95], a[84:87], v[56:71]
    ds_read_b128 v[84:87], v0 offset:27648
    s_waitcnt lgkmcnt(4)
    v_mfma_f32_32x32x16_bf16 v[56:71], v[236:239], a[88:91], v[56:71]
    ds_read_b128 v[88:91], v0 offset:28672
    v_mfma_f32_32x32x16_bf16 v[56:71], v[240:243], a[92:95], v[56:71]
    ds_read_b128 v[92:95], v0 offset:29696
    s_waitcnt lgkmcnt(4)
    v_mfma_f32_32x32x16_bf16 v[56:71], v[72:75], a[96:99], v[56:71]
    ds_read_b128 v[236:239], v0 offset:30720
    v_mfma_f32_32x32x16_bf16 v[56:71], v[76:79], a[100:103], v[56:71]
    ds_read_b128 v[240:243], v0 offset:31744
    s_waitcnt lgkmcnt(4)
    v_mfma_f32_32x32x16_bf16 v[56:71], v[80:83], a[104:107], v[56:71]
    ds_read_b128 v[72:75], v2 offset:16384
    v_mfma_f32_32x32x16_bf16 v[56:71], v[84:87], a[108:111], v[56:71]
    s_waitcnt lgkmcnt(3)
    v_mfma_f32_32x32x16_bf16 v[56:71], v[88:91], a[112:115], v[56:71]
    v_mfma_f32_32x32x16_bf16 v[56:71], v[92:95], a[116:119], v[56:71]
    s_waitcnt lgkmcnt(1)
    v_mfma_f32_32x32x16_bf16 v[56:71], v[236:239], a[120:123], v[56:71]
    v_mfma_f32_32x32x16_bf16 v[56:71], v[240:243], a[124:127], v[56:71]
    s_waitcnt lgkmcnt(0)
    v_mfma_f32_32x32x16_bf16 v[56:71], v[72:75], v[96:99], v[56:71]
    v_mov_b32 v40, 1e-06
    v_mov_b32 v41, 1e-06
    s_nop 9
    v_pk_mul_f32 v[8:9], v[56:57], v[232:233] op_sel:[0,1] op_sel_hi:[1,1]
    v_pk_mul_f32 v[10:11], v[58:59], v[232:233] op_sel:[0,1] op_sel_hi:[1,1]
    v_pk_mul_f32 v[12:13], v[60:61], v[232:233] op_sel:[0,1] op_sel_hi:[1,1]
    v_pk_mul_f32 v[14:15], v[62:63], v[232:233] op_sel:[0,1] op_sel_hi:[1,1]
    v_pk_mul_f32 v[16:17], v[64:65], v[232:233] op_sel:[0,1] op_sel_hi:[1,1]
    v_pk_mul_f32 v[18:19], v[66:67], v[232:233] op_sel:[0,1] op_sel_hi:[1,1]
    v_pk_mul_f32 v[20:21], v[68:69], v[232:233] op_sel:[0,1] op_sel_hi:[1,1]
    v_pk_mul_f32 v[22:23], v[70:71], v[232:233] op_sel:[0,1] op_sel_hi:[1,1]
    v_min_f32 v8, 0, v8
    v_min_f32 v9, 0, v9
    v_min_f32 v10, 0, v10
    v_min_f32 v11, 0, v11
    v_min_f32 v12, 0, v12
    v_min_f32 v13, 0, v13
    v_min_f32 v14, 0, v14
    v_min_f32 v15, 0, v15
    v_min_f32 v16, 0, v16
    v_min_f32 v17, 0, v17
    v_min_f32 v18, 0, v18
    v_min_f32 v19, 0, v19
    v_min_f32 v20, 0, v20
    v_min_f32 v21, 0, v21
    v_min_f32 v22, 0, v22
    v_min_f32 v23, 0, v23
    v_exp_f32 v8, v8
    v_exp_f32 v9, v9
    v_exp_f32 v10, v10
    v_exp_f32 v11, v11
    v_exp_f32 v12, v12
    v_exp_f32 v13, v13
    v_exp_f32 v14, v14
    v_exp_f32 v15, v15
    v_exp_f32 v16, v16
    v_exp_f32 v17, v17
    v_exp_f32 v18, v18
    v_exp_f32 v19, v19
    v_exp_f32 v20, v20
    v_exp_f32 v21, v21
    v_exp_f32 v22, v22
    v_exp_f32 v23, v23
    v_pk_fma_f32 v[24:25], v[56:57], v[232:233], v[40:41] op_sel:[0,0,1] op_sel_hi:[1,0,1]
    v_pk_fma_f32 v[26:27], v[58:59], v[232:233], v[40:41] op_sel:[0,0,1] op_sel_hi:[1,0,1]
    v_pk_fma_f32 v[28:29], v[60:61], v[232:233], v[40:41] op_sel:[0,0,1] op_sel_hi:[1,0,1]
    v_pk_fma_f32 v[30:31], v[62:63], v[232:233], v[40:41] op_sel:[0,0,1] op_sel_hi:[1,0,1]
    v_pk_fma_f32 v[32:33], v[64:65], v[232:233], v[40:41] op_sel:[0,0,1] op_sel_hi:[1,0,1]
    v_pk_fma_f32 v[34:35], v[66:67], v[232:233], v[40:41] op_sel:[0,0,1] op_sel_hi:[1,0,1]
    v_pk_fma_f32 v[36:37], v[68:69], v[232:233], v[40:41] op_sel:[0,0,1] op_sel_hi:[1,0,1]
    v_pk_fma_f32 v[38:39], v[70:71], v[232:233], v[40:41] op_sel:[0,0,1] op_sel_hi:[1,0,1]
    v_max_f32 v24, v40, v24
    v_max_f32 v25, v40, v25
    v_max_f32 v26, v40, v26
    v_max_f32 v27, v40, v27
    v_max_f32 v28, v40, v28
    v_max_f32 v29, v40, v29
    v_max_f32 v30, v40, v30
    v_max_f32 v31, v40, v31
    v_max_f32 v32, v40, v32
    v_max_f32 v33, v40, v33
    v_max_f32 v34, v40, v34
    v_max_f32 v35, v40, v35
    v_max_f32 v36, v40, v36
    v_max_f32 v37, v40, v37
    v_max_f32 v38, v40, v38
    v_max_f32 v39, v40, v39
    v_pk_add_f32 v[24:25], v[24:25], v[8:9]
    v_pk_add_f32 v[26:27], v[26:27], v[10:11]
    v_pk_add_f32 v[28:29], v[28:29], v[12:13]
    v_pk_add_f32 v[30:31], v[30:31], v[14:15]
    v_pk_add_f32 v[32:33], v[32:33], v[16:17]
    v_pk_add_f32 v[34:35], v[34:35], v[18:19]
    v_pk_add_f32 v[36:37], v[36:37], v[20:21]
    v_pk_add_f32 v[38:39], v[38:39], v[22:23]
    v_cvt_pk_bf16_f32 v224, v24, v25
    v_cvt_pk_bf16_f32 v225, v26, v27
    v_cvt_pk_bf16_f32 v226, v28, v29
    v_cvt_pk_bf16_f32 v227, v30, v31
    v_cvt_pk_bf16_f32 v228, v32, v33
    v_cvt_pk_bf16_f32 v229, v34, v35
    v_cvt_pk_bf16_f32 v230, v36, v37
    v_cvt_pk_bf16_f32 v231, v38, v39
    s_lshl_b32 s66, s17, 4
    s_lshl_b32 s20, s18, 2
    s_add_u32 s66, s66, s20
    s_lshl_b32 s66, s66, 12
    s_lshl_b32 s20, s19, 20
    s_add_u32 s66, s66, s20
    s_add_u32 s66, s66, 24117248
    s_lshl_b32 s67, s16, 2
    s_add_u32 s67, s67, s18
    s_lshl_b32 s67, s67, 5
    s_lshl_b32 s20, s17, 1
    s_add_u32 s67, s67, s20
    s_lshl_b32 s67, s67, 10
    s_lshl_b32 s20, s19, 21
    s_add_u32 s67, s67, s20
    s_add_u32 s67, s67, 19922944
    v_lshrrev_b32 v60, 2, v7
    v_lshrrev_b32 v45, 5, v3
    v_lshlrev_b32 v45, 12, v45
    v_add_u32 v60, v60, v45
    v_and_b32 v46, 31, v3
    v_lshrrev_b32 v47, 5, v3
    v_and_b32 v48, 27, v46
    v_cmp_eq_u32 vcc, 16, v48
    s_nop 0
    s_mov_b64 s[64:65], vcc
    v_cmp_gt_u32 vcc, 16, v46
    v_lshlrev_b32 v49, 4, v47
    v_add_u32 v49, 2048, v49
    v_mov_b32 v50, 2176
    v_cndmask_b32 v49, v50, v49, s[64:65]
    v_lshlrev_b32 v50, 5, v47
    v_add_u32 v50, v50, v46
    v_lshlrev_b32 v50, 4, v50
    v_add_u32 v50, 0, v50
    v_cndmask_b32 v96, v49, v50, vcc
    v_add_u32 v96, 102400, v96
    v_lshlrev_b32 v49, 4, v47
    v_add_u32 v49, 2080, v49
    v_mov_b32 v50, 2176
    v_cndmask_b32 v49, v50, v49, s[64:65]
    v_lshlrev_b32 v50, 5, v47
    v_add_u32 v50, v50, v46
    v_lshlrev_b32 v50, 4, v50
    v_add_u32 v50, 1024, v50
    v_cndmask_b32 v97, v49, v50, vcc
    v_add_u32 v97, 102400, v97
    v_lshlrev_b32 v49, 4, v47
    v_add_u32 v49, 2112, v49
    v_mov_b32 v50, 2176
    v_cndmask_b32 v49, v50, v49, s[64:65]
    v_lshlrev_b32 v50, 5, v47
    v_add_u32 v50, v50, v46
    v_lshlrev_b32 v50, 4, v50
    v_add_u32 v50, 256, v50
    v_cndmask_b32 v98, v49, v50, vcc
    v_add_u32 v98, 102400, v98
    v_lshlrev_b32 v49, 4, v47
    v_add_u32 v49, 2144, v49
    v_mov_b32 v50, 2176
    v_cndmask_b32 v49, v50, v49, s[64:65]
    v_lshlrev_b32 v50, 5, v47
    v_add_u32 v50, v50, v46
    v_lshlrev_b32 v50, 4, v50
    v_add_u32 v50, 1280, v50
    v_cndmask_b32 v99, v49, v50, vcc
    v_add_u32 v99, 102400, v99
    s_mul_i32 s20, s18, 2304
    s_add_u32 s20, s20, 102400
    v_add_u32 v61, s20, v0
    v_lshrrev_b32 v62, 2, v7
    v_add_u32 v62, s20, v62
    v_mov_b32 v41, 0
    ds_write_b32 v62, v41 offset:2176
    s_mul_i32 s58, s19, 28672
    s_lshl_b32 s31, s17, 8
    s_add_u32 s58, s58, s31
    s_add_u32 s58, s58, 8192
    s_cmp_eq_u32 s18, 0
    s_cbranch_scc0 L_skip_45
    s_mov_b64 exec, 1
    s_mov_b32 s56, 0
L_poll_46:
    buffer_load_dword v5, off, s[4:7], s58 sc1
    s_add_u32 s56, s56, 1
    s_waitcnt vmcnt(0)
    v_readfirstlane_b32 s30, v5
    s_nop 0
    s_cmp_ge_u32 s30, 16
    s_cbranch_scc1 L_got_47
    s_cmp_lt_u32 s56, 262144
    s_cbranch_scc1 L_poll_46
    s_mov_b32 s57, 1
L_got_47:
    s_mov_b64 exec, -1
    s_cmp_eq_u32 s19, 0
    s_cbranch_scc0 L_skip_48
    s_xor_b32 s20, s58, 2048
    s_mov_b64 exec, 1
    s_mov_b32 s56, 0
L_poll_49:
    buffer_load_dword v5, off, s[4:7], s20 sc1
    s_add_u32 s56, s56, 1
    s_waitcnt vmcnt(0)
    v_readfirstlane_b32 s30, v5
    s_nop 0
    s_cmp_ge_u32 s30, 16
    s_cbranch_scc1 L_got_50
    s_cmp_lt_u32 s56, 262144
    s_cbranch_scc1 L_poll_49
    s_mov_b32 s57, 1
L_got_50:
    s_mov_b64 exec, -1
L_skip_48:
L_skip_45:
    s_barrier
    s_add_u32 s22, s66, 8192
    buffer_load_dword v40, v60, s[4:7], s66 offen offset:2048 sc1
    buffer_load_dword v41, v60, s[4:7], s22 offen offset:2048 sc1
    s_mov_b32 s21, s66
    buffer_load_dwordx4 v[8:11], v0, s[4:7], s21 offen sc1
    buffer_load_dwordx4 v[12:15], v0, s[4:7], s21 offen offset:1024 sc1
    s_add_u32 s21, s21, 4096
    buffer_load_dwordx4 v[16:19], v0, s[4:7], s21 offen sc1
    buffer_load_dwordx4 v[20:23], v0, s[4:7], s21 offen offset:1024 sc1
    s_add_u32 s21, s21, 4096
    buffer_load_dwordx4 v[24:27], v0, s[4:7], s21 offen sc1
    buffer_load_dwordx4 v[28:31], v0, s[4:7], s21 offen offset:1024 sc1
    s_add_u32 s21, s21, 4096
    buffer_load_dwordx4 v[32:35], v0, s[4:7], s21 offen sc1
    buffer_load_dwordx4 v[36:39], v0, s[4:7], s21 offen offset:1024 sc1
    s_mul_i32 s23, s17, 7
    s_add_u32 s23, s23, 0
    s_lshl_b32 s23, s23, 15
    s_lshl_b32 s24, s18, 13
    s_add_u32 s23, s23, s24
    s_add_u32 s23, s23, 4194304
    s_add_u32 s24, s24, 0
    s_mov_b32 m0, s24
    s_nop 0
    buffer_load_dwordx4 v0, s[4:7], s23 offen sc1 lds
    buffer_load_dwordx4 v0, s[4:7], s23 offen offset:1024 sc1 lds
    buffer_load_dwordx4 v0, s[4:7], s23 offen offset:2048 sc1 lds
    buffer_load_dwordx4 v0, s[4:7], s23 offen offset:3072 sc1 lds
    s_add_u32 s23, s23, 4096
    s_add_u32 s24, s24, 4096
    s_mov_b32 m0, s24
    s_nop 0
    buffer_load_dwordx4 v0, s[4:7], s23 offen sc1 lds
    buffer_load_dwordx4 v0, s[4:7], s23 offen offset:1024 sc1 lds
    s_waitcnt vmcnt(14)
    v_add_f32 v40, v40, v41
    v_mov_b32 v41, v40
    s_nop 1
    v_permlane32_swap_b32 v40, v41
    v_add_f32 v40, v40, v41
    ds_write_b32 v62, v40 offset:2048
    s_waitcnt vmcnt(11)
    v_pk_add_f32 v[8:9], v[8:9], v[16:17]
    v_pk_add_f32 v[10:11], v[10:11], v[18:19]
    s_waitcnt vmcnt(10)
    v_pk_add_f32 v[12:13], v[12:13], v[20:21]
    v_pk_add_f32 v[14:15], v[14:15], v[22:23]
    s_waitcnt vmcnt(9)
    v_pk_add_f32 v[8:9], v[8:9], v[24:25]
    v_pk_add_f32 v[10:11], v[10:11], v[26:27]
    s_waitcnt vmcnt(8)
    v_pk_add_f32 v[12:13], v[12:13], v[28:29]
    v_pk_add_f32 v[14:15], v[14:15], v[30:31]
    s_waitcnt vmcnt(7)
    v_pk_add_f32 v[8:9], v[8:9], v[32:33]
    v_pk_add_f32 v[10:11], v[10:11], v[34:35]
    s_waitcnt vmcnt(6)
    v_pk_add_f32 v[12:13], v[12:13], v[36:37]
    v_pk_add_f32 v[14:15], v[14:15], v[38:39]
    ds_write_b128 v61, v[8:11]
    ds_write_b128 v61, v[12:15] offset:1024
    s_mul_i32 s58, s19, 28672
    s_lshl_b32 s31, s16, 8
    s_add_u32 s58, s58, s31
    s_add_u32 s58, s58, 12288
    s_waitcnt lgkmcnt(0)
    s_barrier
    ds_read_b128 v[64:67], v96
    ds_read_b128 v[68:71], v96 offset:2304
    ds_read_b128 v[72:75], v96 offset:4608
    ds_read_b128 v[76:79], v96 offset:6912
    ds_read_b128 v[80:83], v97
    ds_read_b128 v[84:87], v97 offset:2304
    ds_read_b128 v[88:91], v97 offset:4608
    ds_read_b128 v[92:95], v97 offset:6912
    ds_read_b128 v[8:11], v98
    ds_read_b128 v[12:15], v98 offset:2304
    buffer_load_dwordx4 v0, s[4:7], s23 offen offset:2048 sc1 lds
    ds_read_b128 v[16:19], v98 offset:4608
    ds_read_b128 v[20:23], v98 offset:6912
    ds_read_b128 v[24:27], v99
    ds_read_b128 v[28:31], v99 offset:2304
    ds_read_b128 v[32:35], v99 offset:4608
    ds_read_b128 v[36:39], v99 offset:6912
    s_waitcnt lgkmcnt(14)
    v_pk_add_f32 v[64:65], v[64:65], v[68:69]
    v_pk_add_f32 v[66:67], v[66:67], v[70:71]
    s_waitcnt lgkmcnt(12)
    v_pk_add_f32 v[72:73], v[72:73], v[76:77]
    v_pk_add_f32 v[74:75], v[74:75], v[78:79]
    buffer_load_dwordx4 v0, s[4:7], s23 offen offset:3072 sc1 lds
    v_pk_add_f32 v[64:65], v[64:65], v[72:73]
    v_pk_add_f32 v[66:67], v[66:67], v[74:75]
    v_cvt_pk_bf16_f32 v52, v64, v65
    v_cvt_pk_bf16_f32 v53, v66, v67
    s_waitcnt lgkmcnt(10)
    v_pk_add_f32 v[80:81], v[80:81], v[84:85]
    v_pk_add_f32 v[82:83], v[82:83], v[86:87]
    s_waitcnt lgkmcnt(8)
    v_pk_add_f32 v[88:89], v[88:89], v[92:93]
    v_pk_add_f32 v[90:91], v[90:91], v[94:95]
    v_pk_add_f32 v[80:81], v[80:81], v[88:89]
    v_pk_add_f32 v[82:83], v[82:83], v[90:91]
    s_mul_i32 s70, s76, 114688
    s_mul_i32 s71, s18, 28672
    s_add_u32 s70, s70, s71
    s_add_u32 s70, s70, 8388608
    buffer_load_dwordx4 a[192:195], v0, s[4:7], s70 offen sc1
    v_cvt_pk_bf16_f32 v54, v80, v81
    v_cvt_pk_bf16_f32 v55, v82, v83
    s_nop 1
    v_mfma_f32_32x32x16_bf16 v[100:115], v[52:55], v[224:227], 0
    s_waitcnt lgkmcnt(6)
    v_pk_add_f32 v[8:9], v[8:9], v[12:13]
    v_pk_add_f32 v[10:11], v[10:11], v[14:15]
    s_waitcnt lgkmcnt(4)
    v_pk_add_f32 v[16:17], v[16:17], v[20:21]
    v_pk_add_f32 v[18:19], v[18:19], v[22:23]
    v_pk_add_f32 v[8:9], v[8:9], v[16:17]
    v_pk_add_f32 v[10:11], v[10:11], v[18:19]
    v_cvt_pk_bf16_f32 v56, v8, v9
    buffer_load_dwordx4 a[196:199], v0, s[4:7], s70 offen offset:1024 sc1
    v_cvt_pk_bf16_f32 v57, v10, v11
    s_waitcnt lgkmcnt(2)
    v_pk_add_f32 v[24:25], v[24:25], v[28:29]
    v_pk_add_f32 v[26:27], v[26:27], v[30:31]
    s_waitcnt lgkmcnt(0)
    v_pk_add_f32 v[32:33], v[32:33], v[36:37]
    v_pk_add_f32 v[34:35], v[34:35], v[38:39]
    v_pk_add_f32 v[24:25], v[24:25], v[32:33]
    v_pk_add_f32 v[26:27], v[26:27], v[34:35]
    v_cvt_pk_bf16_f32 v58, v24, v25
    v_cvt_pk_bf16_f32 v59, v26, v27
    s_nop 1
    v_mfma_f32_32x32x16_bf16 v[64:79], v[56:59], v[228:231], 0
    buffer_load_dwordx4 a[200:203], v0, s[4:7], s70 offen offset:2048 sc1
    v_add_f32 v44, 1e-06, v108
    v_rcp_f32 v44, v44
    s_nop 0
    v_pk_mul_f32 v[116:117], v[100:101], v[44:45] op_sel_hi:[1,0]
    v_pk_mul_f32 v[118:119], v[102:103], v[44:45] op_sel_hi:[1,0]
    v_pk_mul_f32 v[120:121], v[104:105], v[44:45] op_sel_hi:[1,0]
    v_pk_mul_f32 v[122:123], v[106:107], v[44:45] op_sel_hi:[1,0]
    v_cvt_pk_bf16_f32 v124, v116, v117
    v_cvt_pk_bf16_f32 v125, v118, v119
    v_cvt_pk_bf16_f32 v126, v120, v121
    v_cvt_pk_bf16_f32 v127, v122, v123
    buffer_store_dwordx4 v[124:127], v0, s[4:7], s67 offen sc1
    v_add_f32 v44, 1e-06, v72
    v_rcp_f32 v44, v44
    s_nop 0
    v_pk_mul_f32 v[116:117], v[64:65], v[44:45] op_sel_hi:[1,0]
    v_pk_mul_f32 v[118:119], v[66:67], v[44:45] op_sel_hi:[1,0]
    v_pk_mul_f32 v[120:121], v[68:69], v[44:45] op_sel_hi:[1,0]
    v_pk_mul_f32 v[122:123], v[70:71], v[44:45] op_sel_hi:[1,0]
    v_cvt_pk_bf16_f32 v80, v116, v117
    v_cvt_pk_bf16_f32 v81, v118, v119
    v_cvt_pk_bf16_f32 v82, v120, v121
    v_cvt_pk_bf16_f32 v83, v122, v123
    buffer_store_dwordx4 v[80:83], v0, s[4:7], s67 offen offset:1024 sc1
    s_mul_i32 s23, s17, 7
    s_add_u32 s23, s23, 1
    s_lshl_b32 s23, s23, 15
    s_lshl_b32 s24, s18, 13
    s_add_u32 s23, s23, s24
    s_add_u32 s23, s23, 4194304
    s_add_u32 s24, s24, 32768
    s_mov_b32 m0, s24
    s_nop 0
    buffer_load_dwordx4 v0, s[4:7], s23 offen sc1 lds
    buffer_load_dwordx4 v0, s[4:7], s23 offen offset:1024 sc1 lds
    buffer_load_dwordx4 v0, s[4:7], s23 offen offset:2048 sc1 lds
    buffer_load_dwordx4 v0, s[4:7], s23 offen offset:3072 sc1 lds
    s_add_u32 s23, s23, 4096
    s_add_u32 s24, s24, 4096
    s_mov_b32 m0, s24
    s_nop 0
    buffer_load_dwordx4 v0, s[4:7], s23 offen sc1 lds
    buffer_load_dwordx4 v0, s[4:7], s23 offen offset:1024 sc1 lds
    buffer_load_dwordx4 v0, s[4:7], s23 offen offset:2048 sc1 lds
    buffer_load_dwordx4 v0, s[4:7], s23 offen offset:3072 sc1 lds
    buffer_load_dwordx4 a[204:207], v0, s[4:7], s70 offen offset:3072 sc1
    s_add_u32 s70, s70, 7168
    buffer_load_dwordx4 a[208:211], v0, s[4:7], s70 offen sc1
    buffer_load_dwordx4 a[212:215], v0, s[4:7], s70 offen offset:1024 sc1
    s_waitcnt vmcnt(11)
    s_waitcnt lgkmcnt(0)
    s_barrier
    s_cmp_eq_u32 s18, 0
    s_cbranch_scc0 L_skip_51
    s_mov_b64 exec, 1
    buffer_atomic_add v4, off, s[4:7], s58
    s_mov_b64 exec, -1
L_skip_51:
    s_cmp_eq_u32 s19, 0
    s_cbranch_scc0 L_skip_52
    v_lshrrev_b32 v113, 2, v7
    s_mul_i32 s20, s17, 7
    s_add_u32 s20, s20, s18
    s_add_u32 s20, s20, 0
    s_lshl_b32 s20, s20, 9
    s_add_u32 s20, s20, 7864320
    buffer_load_dword v100, v113, s[4:7], s20 offen sc1
    buffer_load_dword v101, v113, s[4:7], s20 offen offset:128 sc1
    buffer_load_dword v102, v113, s[4:7], s20 offen offset:256 sc1
    buffer_load_dword v103, v113, s[4:7], s20 offen offset:384 sc1
    s_mul_i32 s20, s17, 7
    s_add_u32 s20, s20, s18
    s_add_u32 s20, s20, 4
    s_lshl_b32 s20, s20, 9
    s_add_u32 s20, s20, 7864320
    buffer_load_dword v104, v113, s[4:7], s20 offen sc1
    buffer_load_dword v105, v113, s[4:7], s20 offen offset:128 sc1
    buffer_load_dword v106, v113, s[4:7], s20 offen offset:256 sc1
    buffer_load_dword v107, v113, s[4:7], s20 offen offset:384 sc1
    s_waitcnt vmcnt(6)
    v_add_f32 v100, v100, v101
    s_waitcnt vmcnt(4)
    v_add_f32 v102, v102, v103
    v_add_f32 v100, v100, v102
    v_cvt_pk_bf16_f32 v108, v100, v100
    v_lshlrev_b32 v112, 16, v108
    v_sub_f32 v112, v100, v112
    v_cvt_pk_bf16_f32 v108, v100, v112
    v_and_b32 v109, 65535, v108
    v_mov_b32 v110, 0
    v_mov_b32 v111, 0
    v_cndmask_b32 v108, v108, v110, s[62:63]
    v_cndmask_b32 v109, v109, v110, s[62:63]
    s_lshl_b32 s20, s18, 10
    s_add_u32 s20, s20, 153600
    v_add_u32 v112, s20, v0
    ds_write_b128 v112, v[108:111]
    s_waitcnt vmcnt(2)
    v_add_f32 v104, v104, v105
    s_waitcnt vmcnt(0)
    v_add_f32 v106, v106, v107
    v_add_f32 v104, v104, v106
    v_cvt_pk_bf16_f32 v108, v104, v104
    v_lshlrev_b32 v112, 16, v108
    v_sub_f32 v112, v104, v112
    v_cvt_pk_bf16_f32 v108, v104, v112
    v_and_b32 v109, 65535, v108
    v_mov_b32 v110, 0
    v_mov_b32 v111, 0
    v_cndmask_b32 v108, v108, v110, s[62:63]
    v_cndmask_b32 v109, v109, v110, s[62:63]
    s_lshl_b32 s20, s18, 10
    s_add_u32 s20, s20, 157696
    v_add_u32 v112, s20, v0
    ds_write_b128 v112, v[108:111]
L_skip_52:
    buffer_load_dwordx4 a[216:219], v0, s[4:7], s70 offen offset:2048 sc1
    buffer_load_dwordx4 a[220:223], v0, s[4:7], s70 offen offset:3072 sc1
    s_add_u32 s70, s70, 7168
    buffer_load_dwordx4 a[224:227], v0, s[4:7], s70 offen sc1
    buffer_load_dwordx4 a[228:231], v0, s[4:7], s70 offen offset:1024 sc1
    buffer_load_dwordx4 a[232:235], v0, s[4:7], s70 offen offset:2048 sc1
    buffer_load_dwordx4 a[236:239], v0, s[4:7], s70 offen offset:3072 sc1
    s_add_u32 s70, s70, 7168
    buffer_load_dwordx4 a[240:243], v0, s[4:7], s70 offen sc1
    buffer_load_dwordx4 a[244:247], v0, s[4:7], s70 offen offset:1024 sc1
    buffer_load_dwordx4 a[248:251], v0, s[4:7], s70 offen offset:2048 sc1
    buffer_load_dwordx4 a[252:255], v0, s[4:7], s70 offen offset:3072 sc1
    s_mul_i32 s72, s76, 114688
    s_mul_i32 s73, s18, 28672
    s_add_u32 s72, s72, s73
    s_add_u32 s72, s72, 8388608
    s_add_u32 s72, s72, 4096
    buffer_load_dwordx4 v[128:131], v0, s[4:7], s72 offen sc1
    buffer_load_dwordx4 v[132:135], v0, s[4:7], s72 offen offset:1024 sc1
    buffer_load_dwordx4 v[136:139], v0, s[4:7], s72 offen offset:2048 sc1
    s_add_u32 s72, s72, 7168
    buffer_load_dwordx4 v[140:143], v0, s[4:7], s72 offen sc1
    buffer_load_dwordx4 v[144:147], v0, s[4:7], s72 offen offset:1024 sc1
    buffer_load_dwordx4 v[148:151], v0, s[4:7], s72 offen offset:2048 sc1
    s_add_u32 s72, s72, 7168
    buffer_load_dwordx4 v[152:155], v0, s[4:7], s72 offen sc1
    buffer_load_dwordx4 v[156:159], v0, s[4:7], s72 offen offset:1024 sc1
    buffer_load_dwordx4 v[160:163], v0, s[4:7], s72 offen offset:2048 sc1
    s_add_u32 s72, s72, 7168
    buffer_load_dwordx4 v[164:167], v0, s[4:7], s72 offen sc1
    s_lshl_b32 s66, s74, 15
    s_lshl_b32 s20, s18, 13
    s_add_u32 s66, s66, s20
    s_lshl_b32 s20, s19, 21
    s_add_u32 s66, s66, s20
    s_add_u32 s66, s66, 19922944
    s_lshl_b32 s67, s75, 15
    s_lshl_b32 s20, s18, 13
    s_add_u32 s67, s67, s20
    s_lshl_b32 s20, s19, 21
    s_add_u32 s67, s67, s20
    s_add_u32 s67, s67, 19922944
    s_cmp_eq_u32 s18, 0
    s_cbranch_scc0 L_skip_53
    s_mov_b64 exec, 1
    s_mov_b32 s56, 0
L_poll_54:
    buffer_load_dword v5, off, s[4:7], s58 sc1
    s_add_u32 s56, s56, 1
    s_waitcnt vmcnt(0)
    v_readfirstlane_b32 s30, v5
    s_nop 0
    s_cmp_ge_u32 s30, 16
    s_cbranch_scc1 L_got_55
    s_cmp_lt_u32 s56, 262144
    s_cbranch_scc1 L_poll_54
    s_mov_b32 s57, 1
L_got_55:
    s_mov_b64 exec, -1
L_skip_53:
    s_barrier
    buffer_load_dwordx4 a[0:3], v0, s[4:7], s66 offen sc1
    buffer_load_dwordx4 a[32:35], v0, s[4:7], s67 offen sc1
    buffer_load_dwordx4 a[4:7], v0, s[4:7], s66 offen offset:1024 sc1
    buffer_load_dwordx4 a[36:39], v0, s[4:7], s67 offen offset:1024 sc1
    buffer_load_dwordx4 a[8:11], v0, s[4:7], s66 offen offset:2048 sc1
    buffer_load_dwordx4 a[40:43], v0, s[4:7], s67 offen offset:2048 sc1
    buffer_load_dwordx4 a[12:15], v0, s[4:7], s66 offen offset:3072 sc1
    buffer_load_dwordx4 a[44:47], v0, s[4:7], s67 offen offset:3072 sc1
    s_add_u32 s66, s66, 4096
    s_add_u32 s67, s67, 4096
    buffer_load_dwordx4 a[16:19], v0, s[4:7], s66 offen sc1
    buffer_load_dwordx4 a[48:51], v0, s[4:7], s67 offen sc1
    buffer_load_dwordx4 a[20:23], v0, s[4:7], s66 offen offset:1024 sc1
    buffer_load_dwordx4 a[52:55], v0, s[4:7], s67 offen offset:1024 sc1
    s_lshl_b32 s25, s19, 1
    s_cmp_eq_u32 s19, 0
    s_cbranch_scc0 L_skip_56
    s_lshl_b32 s20, s25, 21
    s_lshl_b32 s21, s74, 15
    s_add_u32 s20, s20, s21
    s_lshl_b32 s21, s76, 11
    s_add_u32 s20, s20, s21
    s_add_u32 s20, s20, 10485760
    buffer_load_dwordx4 v[244:247], v0, s[4:7], s20 offen sc1
    buffer_load_dwordx4 v[248:251], v0, s[4:7], s20 offen offset:1024 sc1
L_skip_56:
    s_xor_b32 s20, s18, 1
    s_mul_i32 s20, s20, 3
    s_add_u32 s20, s20, 0
    s_lshl_b32 s20, s20, 12
    s_add_u32 s20, s20, 98304
    v_add_u32 v96, s20, v0
    s_xor_b32 s20, s18, 2
    s_mul_i32 s20, s20, 3
    s_add_u32 s20, s20, 1
    s_lshl_b32 s20, s20, 12
    s_add_u32 s20, s20, 98304
    v_add_u32 v97, s20, v0
    s_xor_b32 s20, s18, 3
    s_mul_i32 s20, s20, 3
    s_add_u32 s20, s20, 2
    s_lshl_b32 s20, s20, 12
    s_add_u32 s20, s20, 98304
    v_add_u32 v98, s20, v0
    s_mul_i32 s20, s18, 12288
    s_add_u32 s20, s20, 98304
    v_add_u32 v99, s20, v0
    s_waitcnt vmcnt(11)
    v_mfma_f32_32x32x16_bf16 v[8:23], a[128:131], a[0:3], 0
    buffer_load_dwordx4 a[24:27], v0, s[4:7], s66 offen offset:2048 sc1
    v_mfma_f32_32x32x16_bf16 v[24:39], a[160:163], a[0:3], 0
    s_waitcnt vmcnt(11)
    v_mfma_f32_32x32x16_bf16 v[40:55], a[128:131], a[32:35], 0
    buffer_load_dwordx4 a[56:59], v0, s[4:7], s67 offen offset:2048 sc1
    v_mfma_f32_32x32x16_bf16 v[56:71], a[160:163], a[32:35], 0
    s_waitcnt vmcnt(11)
    v_mfma_f32_32x32x16_bf16 v[8:23], a[132:135], a[4:7], v[8:23]
    buffer_load_dwordx4 a[28:31], v0, s[4:7], s66 offen offset:3072 sc1
    v_mfma_f32_32x32x16_bf16 v[24:39], a[164:167], a[4:7], v[24:39]
    s_waitcnt vmcnt(11)
    v_mfma_f32_32x32x16_bf16 v[40:55], a[132:135], a[36:39], v[40:55]
    buffer_load_dwordx4 a[60:63], v0, s[4:7], s67 offen offset:3072 sc1
    v_mfma_f32_32x32x16_bf16 v[56:71], a[164:167], a[36:39], v[56:71]
    s_waitcnt vmcnt(11)
    v_mfma_f32_32x32x16_bf16 v[8:23], a[136:139], a[8:11], v[8:23]
    v_mfma_f32_32x32x16_bf16 v[24:39], a[168:171], a[8:11], v[24:39]
    s_waitcnt vmcnt(10)
    v_mfma_f32_32x32x16_bf16 v[40:55], a[136:139], a[40:43], v[40:55]
    v_mfma_f32_32x32x16_bf16 v[56:71], a[168:171], a[40:43], v[56:71]
    s_waitcnt vmcnt(9)
    v_mfma_f32_32x32x16_bf16 v[8:23], a[140:143], a[12:15], v[8:23]
    v_mfma_f32_32x32x16_bf16 v[24:39], a[172:175], a[12:15], v[24:39]
    s_waitcnt vmcnt(8)
    v_mfma_f32_32x32x16_bf16 v[40:55], a[140:143], a[44:47], v[40:55]
    v_mfma_f32_32x32x16_bf16 v[56:71], a[172:175], a[44:47], v[56:71]
    s_waitcnt vmcnt(7)
    v_mfma_f32_32x32x16_bf16 v[8:23], a[144:147], a[16:19], v[8:23]
    v_mfma_f32_32x32x16_bf16 v[24:39], a[176:179], a[16:19], v[24:39]
    s_waitcnt vmcnt(6)
    v_mfma_f32_32x32x16_bf16 v[40:55], a[144:147], a[48:51], v[40:55]
    v_mfma_f32_32x32x16_bf16 v[56:71], a[176:179], a[48:51], v[56:71]
    s_waitcnt vmcnt(5)
    v_mfma_f32_32x32x16_bf16 v[8:23], a[148:151], a[20:23], v[8:23]
    v_mfma_f32_32x32x16_bf16 v[24:39], a[180:183], a[20:23], v[24:39]
    s_waitcnt vmcnt(4)
    v_mfma_f32_32x32x16_bf16 v[40:55], a[148:151], a[52:55], v[40:55]
    v_mfma_f32_32x32x16_bf16 v[56:71], a[180:183], a[52:55], v[56:71]
    s_lshl_b32 s25, s19, 1
    s_add_u32 s68, s25, 1
    s_lshl_b32 s78, s68, 21
    s_lshl_b32 s21, s74, 15
    s_add_u32 s78, s78, s21
    s_lshl_b32 s21, s76, 11
    s_add_u32 s78, s78, s21
    s_add_u32 s78, s78, 10485760
    s_lshl_b32 s79, s68, 18
    s_lshl_b32 s22, s74, 12
    s_add_u32 s79, s79, s22
    s_lshl_b32 s22, s76, 8
    s_add_u32 s79, s79, s22
    s_add_u32 s79, s79, 18874368
    s_mul_i32 s58, s19, 28672
    s_lshl_b32 s31, s16, 8
    s_add_u32 s58, s58, s31
    s_add_u32 s58, s58, 16384
    s_waitcnt vmcnt(2)
    v_mfma_f32_32x32x16_bf16 v[56:71], a[184:187], a[56:59], v[56:71]
    s_waitcnt vmcnt(0)
    v_mfma_f32_32x32x16_bf16 v[56:71], a[188:191], a[60:63], v[56:71]
    v_mfma_f32_32x32x16_bf16 v[40:55], a[152:155], a[56:59], v[40:55]
    v_lshlrev_b32 v80, 16, v244
    v_and_b32 v81, 4294901760, v244
    v_lshlrev_b32 v82, 16, v245
    v_and_b32 v83, 4294901760, v245
    v_lshlrev_b32 v84, 16, v246
    v_and_b32 v85, 4294901760, v246
    v_lshlrev_b32 v86, 16, v247
    v_and_b32 v87, 4294901760, v247
    v_mfma_f32_32x32x16_bf16 v[40:55], a[156:159], a[60:63], v[40:55]
    v_lshlrev_b32 v88, 16, v248
    v_and_b32 v89, 4294901760, v248
    v_lshlrev_b32 v90, 16, v249
    v_and_b32 v91, 4294901760, v249
    v_lshlrev_b32 v92, 16, v250
    v_and_b32 v93, 4294901760, v250
    v_lshlrev_b32 v94, 16, v251
    v_and_b32 v95, 4294901760, v251
    ds_write_b128 v98, v[56:59]
    ds_write_b128 v98, v[60:63] offset:1024
    v_mfma_f32_32x32x16_bf16 v[24:39], a[184:187], a[24:27], v[24:39]
    ds_write_b128 v98, v[64:67] offset:2048
    ds_write_b128 v98, v[68:71] offset:3072
    v_mfma_f32_32x32x16_bf16 v[24:39], a[188:191], a[28:31], v[24:39]
    ds_write_b128 v97, v[40:43]
    ds_write_b128 v97, v[44:47] offset:1024
    v_mfma_f32_32x32x16_bf16 v[8:23], a[152:155], a[24:27], v[8:23]
    ds_write_b128 v97, v[48:51] offset:2048
    ds_write_b128 v97, v[52:55] offset:3072
    v_mfma_f32_32x32x16_bf16 v[8:23], a[156:159], a[28:31], v[8:23]
    s_nop 5
    ds_write_b128 v96, v[24:27]
    ds_write_b128 v96, v[28:31] offset:1024
    ds_write_b128 v96, v[32:35] offset:2048
    ds_write_b128 v96, v[36:39] offset:3072
    s_waitcnt lgkmcnt(0)
    s_barrier
    ds_read_b128 v[24:27], v99
    ds_read_b128 v[28:31], v99 offset:1024
    ds_read_b128 v[32:35], v99 offset:2048
    ds_read_b128 v[36:39], v99 offset:3072
    ds_read_b128 v[40:43], v99 offset:4096
    ds_read_b128 v[44:47], v99 offset:5120
    ds_read_b128 v[48:51], v99 offset:6144
    ds_read_b128 v[52:55], v99 offset:7168
    ds_read_b128 v[56:59], v99 offset:8192
    ds_read_b128 v[60:63], v99 offset:9216
    ds_read_b128 v[64:67], v99 offset:10240
    ds_read_b128 v[68:71], v99 offset:11264
    v_pk_add_f32 v[8:9], v[8:9], v[80:81]
    v_pk_add_f32 v[10:11], v[10:11], v[82:83]
    v_pk_add_f32 v[12:13], v[12:13], v[84:85]
    v_pk_add_f32 v[14:15], v[14:15], v[86:87]
    v_pk_add_f32 v[16:17], v[16:17], v[88:89]
    v_pk_add_f32 v[18:19], v[18:19], v[90:91]
    v_pk_add_f32 v[20:21], v[20:21], v[92:93]
    v_pk_add_f32 v[22:23], v[22:23], v[94:95]
    s_waitcnt lgkmcnt(11)
    v_pk_add_f32 v[8:9], v[8:9], v[24:25]
    v_pk_add_f32 v[10:11], v[10:11], v[26:27]
    s_waitcnt lgkmcnt(10)
    v_pk_add_f32 v[12:13], v[12:13], v[28:29]
    v_pk_add_f32 v[14:15], v[14:15], v[30:31]
    s_waitcnt lgkmcnt(9)
    v_pk_add_f32 v[16:17], v[16:17], v[32:33]
    v_pk_add_f32 v[18:19], v[18:19], v[34:35]
    s_waitcnt lgkmcnt(8)
    v_pk_add_f32 v[20:21], v[20:21], v[36:37]
    v_pk_add_f32 v[22:23], v[22:23], v[38:39]
    s_waitcnt lgkmcnt(7)
    v_pk_add_f32 v[8:9], v[8:9], v[40:41]
    v_pk_add_f32 v[10:11], v[10:11], v[42:43]
    s_waitcnt lgkmcnt(6)
    v_pk_add_f32 v[12:13], v[12:13], v[44:45]
    v_pk_add_f32 v[14:15], v[14:15], v[46:47]
    s_waitcnt lgkmcnt(5)
    v_pk_add_f32 v[16:17], v[16:17], v[48:49]
    v_pk_add_f32 v[18:19], v[18:19], v[50:51]
    s_waitcnt lgkmcnt(4)
    v_pk_add_f32 v[20:21], v[20:21], v[52:53]
    v_pk_add_f32 v[22:23], v[22:23], v[54:55]
    s_waitcnt lgkmcnt(3)
    v_pk_add_f32 v[8:9], v[8:9], v[56:57]
    v_pk_add_f32 v[10:11], v[10:11], v[58:59]
    s_waitcnt lgkmcnt(2)
    v_pk_add_f32 v[12:13], v[12:13], v[60:61]
    v_pk_add_f32 v[14:15], v[14:15], v[62:63]
    s_waitcnt lgkmcnt(1)
    v_pk_add_f32 v[16:17], v[16:17], v[64:65]
    v_pk_add_f32 v[18:19], v[18:19], v[66:67]
    s_waitcnt lgkmcnt(0)
    v_pk_add_f32 v[20:21], v[20:21], v[68:69]
    v_pk_add_f32 v[22:23], v[22:23], v[70:71]
    v_cvt_pk_bf16_f32 v244, v8, v9
    v_cvt_pk_bf16_f32 v245, v10, v11
    v_cvt_pk_bf16_f32 v246, v12, v13
    v_cvt_pk_bf16_f32 v247, v14, v15
    v_cvt_pk_bf16_f32 v248, v16, v17
    v_cvt_pk_bf16_f32 v249, v18, v19
    v_cvt_pk_bf16_f32 v250, v20, v21
    v_cvt_pk_bf16_f32 v251, v22, v23
    buffer_store_dwordx4 v[244:247], v0, s[4:7], s78 offen sc1
    buffer_store_dwordx4 v[248:251], v0, s[4:7], s78 offen offset:1024 sc1
    v_pk_mul_f32 v[228:229], v[8:9], v[8:9]
    v_pk_mul_f32 v[230:231], v[10:11], v[10:11]
    v_pk_add_f32 v[224:225], v[8:9], v[10:11]
    v_pk_add_f32 v[226:227], v[12:13], v[14:15]
    v_pk_fma_f32 v[228:229], v[12:13], v[12:13], v[228:229]
    v_pk_fma_f32 v[230:231], v[14:15], v[14:15], v[230:231]
    v_pk_fma_f32 v[228:229], v[16:17], v[16:17], v[228:229]
    v_pk_add_f32 v[224:225], v[224:225], v[16:17]
    v_pk_add_f32 v[226:227], v[226:227], v[18:19]
    v_pk_fma_f32 v[230:231], v[18:19], v[18:19], v[230:231]
    v_pk_fma_f32 v[228:229], v[20:21], v[20:21], v[228:229]
    v_pk_add_f32 v[224:225], v[224:225], v[20:21]
    v_pk_add_f32 v[226:227], v[226:227], v[22:23]
    v_pk_fma_f32 v[230:231], v[22:23], v[22:23], v[230:231]
    v_pk_add_f32 v[224:225], v[224:225], v[226:227]
    v_pk_add_f32 v[228:229], v[228:229], v[230:231]
    v_add_f32 v240, v224, v225
    v_add_f32 v241, v228, v229
    v_mov_b32 v224, v240
    v_mov_b32 v225, v241
    s_nop 0
    v_permlane32_swap_b32 v240, v224
    v_permlane32_swap_b32 v241, v225
    v_add_f32 v240, v240, v224
    v_add_f32 v241, v241, v225
    v_lshrrev_b32 v224, 1, v7
    buffer_store_dwordx2 v[240:241], v224, s[4:7], s79 offen sc1
    s_mul_i32 s23, s17, 7
    s_add_u32 s23, s23, 2
    s_lshl_b32 s23, s23, 15
    s_lshl_b32 s24, s18, 13
    s_add_u32 s23, s23, s24
    s_add_u32 s23, s23, 4194304
    s_add_u32 s24, s24, 65536
    s_mov_b32 m0, s24
    s_nop 0
    buffer_load_dwordx4 v0, s[4:7], s23 offen sc1 lds
    buffer_load_dwordx4 v0, s[4:7], s23 offen offset:1024 sc1 lds
    buffer_load_dwordx4 v0, s[4:7], s23 offen offset:2048 sc1 lds
    buffer_load_dwordx4 v0, s[4:7], s23 offen offset:3072 sc1 lds
    s_add_u32 s23, s23, 4096
    s_add_u32 s24, s24, 4096
    s_mov_b32 m0, s24
    s_nop 0
    buffer_load_dwordx4 v0, s[4:7], s23 offen sc1 lds
    buffer_load_dwordx4 v0, s[4:7], s23 offen offset:1024 sc1 lds
    buffer_load_dwordx4 v0, s[4:7], s23 offen offset:2048 sc1 lds
    buffer_load_dwordx4 v0, s[4:7], s23 offen offset:3072 sc1 lds
    buffer_load_dwordx4 v[168:171], v0, s[4:7], s72 offen offset:1024 sc1
    buffer_load_dwordx4 v[172:175], v0, s[4:7], s72 offen offset:2048 sc1
    s_mul_i32 s72, s77, 114688
    s_mul_i32 s73, s18, 28672
    s_add_u32 s72, s72, s73
    s_add_u32 s72, s72, 8388608
    s_add_u32 s72, s72, 4096
    buffer_load_dwordx4 v[176:179], v0, s[4:7], s72 offen sc1
    s_waitcnt vmcnt(11)
    s_waitcnt lgkmcnt(0)
    s_barrier
    s_cmp_eq_u32 s18, 0
    s_cbranch_scc0 L_skip_57
    s_mov_b64 exec, 1
    buffer_atomic_add v4, off, s[4:7], s58
    s_mov_b64 exec, -1
L_skip_57:
    s_cmp_lg_u32 s18, 0
    s_cbranch_scc0 L_skip_58
    s_sub_u32 s20, s18, 1
    s_mul_i32 s23, s20, 11264
    s_mul_i32 s21, s17, 7
    s_add_u32 s21, s21, 3
    s_lshl_b32 s21, s21, 15
    s_add_u32 s21, s21, s23
    s_add_u32 s21, s21, 4194304
    s_add_u32 s22, s23, 98304
    s_mov_b32 m0, s22
    s_nop 0
    buffer_load_dwordx4 v0, s[4:7], s21 offen sc1 lds
    buffer_load_dwordx4 v0, s[4:7], s21 offen offset:1024 sc1 lds
    buffer_load_dwordx4 v0, s[4:7], s21 offen offset:2048 sc1 lds
    buffer_load_dwordx4 v0, s[4:7], s21 offen offset:3072 sc1 lds
    s_add_u32 s21, s21, 4096
    s_add_u32 s22, s22, 4096
    s_mov_b32 m0, s22
    s_nop 0
    buffer_load_dwordx4 v0, s[4:7], s21 offen sc1 lds
    buffer_load_dwordx4 v0, s[4:7], s21 offen offset:1024 sc1 lds
    buffer_load_dwordx4 v0, s[4:7], s21 offen offset:2048 sc1 lds
    buffer_load_dwordx4 v0, s[4:7], s21 offen offset:3072 sc1 lds
    s_add_u32 s21, s21, 4096
    s_add_u32 s22, s22, 4096
    s_mov_b32 m0, s22
    s_nop 0
    buffer_load_dwordx4 v0, s[4:7], s21 offen sc1 lds
    buffer_load_dwordx4 v0, s[4:7], s21 offen offset:1024 sc1 lds
    buffer_load_dwordx4 v0, s[4:7], s21 offen offset:2048 sc1 lds
L_skip_58:
    buffer_load_dwordx4 v[180:183], v0, s[4:7], s72 offen offset:1024 sc1
    buffer_load_dwordx4 v[184:187], v0, s[4:7], s72 offen offset:2048 sc1
    s_add_u32 s72, s72, 7168
    buffer_load_dwordx4 v[188:191], v0, s[4:7], s72 offen sc1
    buffer_load_dwordx4 v[192:195], v0, s[4:7], s72 offen offset:1024 sc1
    buffer_load_dwordx4 v[196:199], v0, s[4:7], s72 offen offset:2048 sc1
    s_add_u32 s72, s72, 7168
    buffer_load_dwordx4 v[200:203], v0, s[4:7], s72 offen sc1
    buffer_load_dwordx4 v[204:207], v0, s[4:7], s72 offen offset:1024 sc1
    buffer_load_dwordx4 v[208:211], v0, s[4:7], s72 offen offset:2048 sc1
    s_add_u32 s72, s72, 7168
    buffer_load_dwordx4 v[212:215], v0, s[4:7], s72 offen sc1
    buffer_load_dwordx4 v[216:219], v0, s[4:7], s72 offen offset:1024 sc1
    buffer_load_dwordx4 v[220:223], v0, s[4:7], s72 offen offset:2048 sc1
    s_mul_i32 s70, s77, 114688
    s_mul_i32 s71, s18, 28672
    s_add_u32 s70, s70, s71
    s_add_u32 s70, s70, 8388608
    buffer_load_dwordx4 a[128:131], v0, s[4:7], s70 offen sc1
    buffer_load_dwordx4 a[132:135], v0, s[4:7], s70 offen offset:1024 sc1
    s_cmp_eq_u32 s18, 0
    s_cbranch_scc0 L_skip_59
    s_mov_b64 exec, 1
    s_mov_b32 s56, 0
L_poll_60:
    buffer_load_dword v5, off, s[4:7], s58 sc1
    s_add_u32 s56, s56, 1
    s_waitcnt vmcnt(0)
    v_readfirstlane_b32 s30, v5
    s_nop 0
    s_cmp_ge_u32 s30, 16
    s_cbranch_scc1 L_got_61
    s_cmp_lt_u32 s56, 262144
    s_cbranch_scc1 L_poll_60
    s_mov_b32 s57, 1
L_got_61:
    s_mov_b64 exec, -1
L_skip_59:
    s_barrier
    s_lshl_b32 s25, s19, 1
    s_add_u32 s25, s25, 1
    s_lshl_b32 s20, s16, 2
    s_add_u32 s20, s20, s18
    s_lshl_b32 s21, s25, 18
    s_lshl_b32 s22, s20, 12
    s_add_u32 s21, s21, s22
    s_add_u32 s21, s21, 18874368
    s_lshl_b32 s79, s25, 21
    s_lshl_b32 s22, s20, 15
    s_add_u32 s79, s79, s22
    s_add_u32 s79, s79, 10485760
    buffer_load_dwordx4 a[0:3], v0, s[4:7], s79 offen sc1
    buffer_load_dwordx4 a[4:7], v0, s[4:7], s79 offen offset:1024 sc1
    v_and_b32 v5, 3, v3
    v_bfe_u32 v6, v3, 3, 2
    v_lshl_add_u32 v5, v6, 2, v5
    v_lshlrev_b32 v5, 4, v5
    v_bfe_u32 v6, v3, 2, 1
    v_lshl_add_u32 v5, v6, 8, v5
    v_lshrrev_b32 v6, 5, v3
    v_lshl_add_u32 v6, v6, 11, v5
    buffer_load_dwordx4 v[56:59], v6, s[4:7], s21 offen sc1
    buffer_load_dwordx4 v[60:63], v6, s[4:7], s21 offen offset:512 sc1
    buffer_load_dwordx4 v[64:67], v6, s[4:7], s21 offen offset:1024 sc1
    buffer_load_dwordx4 v[68:71], v6, s[4:7], s21 offen offset:1536 sc1
    buffer_load_dwordx4 a[8:11], v0, s[4:7], s79 offen offset:2048 sc1
    buffer_load_dwordx4 a[12:15], v0, s[4:7], s79 offen offset:3072 sc1
    s_add_u32 s79, s79, 4096
    buffer_load_dwordx4 a[16:19], v0, s[4:7], s79 offen sc1
    buffer_load_dwordx4 a[20:23], v0, s[4:7], s79 offen offset:1024 sc1
    buffer_load_dwordx4 a[24:27], v0, s[4:7], s79 offen offset:2048 sc1
    buffer_load_dwordx4 a[28:31], v0, s[4:7], s79 offen offset:3072 sc1
    s_add_u32 s79, s79, 4096
    buffer_load_dwordx4 a[32:35], v0, s[4:7], s79 offen sc1
    buffer_load_dwordx4 a[36:39], v0, s[4:7], s79 offen offset:1024 sc1
    buffer_load_dwordx4 a[40:43], v0, s[4:7], s79 offen offset:2048 sc1
    buffer_load_dwordx4 a[44:47], v0, s[4:7], s79 offen offset:3072 sc1
    s_lshl_b32 s69, s16, 2
    s_add_u32 s69, s69, s18
    s_mul_i32 s69, s69, 114688
    s_mul_i32 s20, s17, 7168
    s_add_u32 s69, s69, s20
    s_mul_i32 s20, s19, 7340032
    s_add_u32 s69, s69, s20
    s_add_u32 s69, s69, 26214400
    s_mul_i32 s84, s19, 28672
    s_lshl_b32 s31, s16, 8
    s_add_u32 s84, s84, s31
    s_add_u32 s84, s84, 20480
    s_mul_i32 s85, s19, 28672
    s_lshl_b32 s31, s16, 8
    s_add_u32 s85, s85, s31
    s_add_u32 s85, s85, 24576
    s_mul_i32 s86, s19, 28672
    s_lshl_b32 s31, s16, 8
    s_add_u32 s86, s86, s31
    s_add_u32 s86, s86, 32768
    s_waitcnt vmcnt(29)
    s_barrier
    ds_read_b128 v[72:75], v0
    ds_read_b128 v[76:79], v0 offset:32768
    ds_read_b128 v[80:83], v0 offset:1024
    ds_read_b128 v[84:87], v0 offset:33792
    ds_read_b128 v[88:91], v0 offset:2048
    ds_read_b128 v[92:95], v0 offset:34816
    s_waitcnt vmcnt(15) lgkmcnt(4)
    v_mfma_f32_32x32x16_bf16 v[8:23], v[72:75], a[0:3], 0
    ds_read_b128 v[96:99], v0 offset:3072
    s_add_u32 s79, s79, 4096
    buffer_load_dwordx4 a[48:51], v0, s[4:7], s79 offen sc1
    v_mfma_f32_32x32x16_bf16 v[24:39], v[76:79], a[0:3], 0
    ds_read_b128 v[100:103], v0 offset:35840
    s_waitcnt vmcnt(15) lgkmcnt(4)
    v_mfma_f32_32x32x16_bf16 v[8:23], v[80:83], a[4:7], v[8:23]
    ds_read_b128 v[72:75], v0 offset:4096
    buffer_load_dwordx4 a[52:55], v0, s[4:7], s79 offen offset:1024 sc1
    v_mfma_f32_32x32x16_bf16 v[24:39], v[84:87], a[4:7], v[24:39]
    ds_read_b128 v[76:79], v0 offset:36864
    s_waitcnt vmcnt(11) lgkmcnt(4)
    v_mfma_f32_32x32x16_bf16 v[8:23], v[88:91], a[8:11], v[8:23]
    ds_read_b128 v[80:83], v0 offset:5120
    buffer_load_dwordx4 a[56:59], v0, s[4:7], s79 offen offset:2048 sc1
    v_mfma_f32_32x32x16_bf16 v[24:39], v[92:95], a[8:11], v[24:39]
    ds_read_b128 v[84:87], v0 offset:37888
    s_waitcnt vmcnt(11) lgkmcnt(4)
    v_mfma_f32_32x32x16_bf16 v[8:23], v[96:99], a[12:15], v[8:23]
    ds_read_b128 v[88:91], v0 offset:6144
    buffer_load_dwordx4 a[60:63], v0, s[4:7], s79 offen offset:3072 sc1
    v_mfma_f32_32x32x16_bf16 v[24:39], v[100:103], a[12:15], v[24:39]
    ds_read_b128 v[92:95], v0 offset:38912
    s_waitcnt vmcnt(11) lgkmcnt(4)
    v_mfma_f32_32x32x16_bf16 v[8:23], v[72:75], a[16:19], v[8:23]
    ds_read_b128 v[96:99], v0 offset:7168
    s_add_u32 s79, s79, 4096
    buffer_load_dwordx4 a[64:67], v0, s[4:7], s79 offen sc1
    v_pk_add_f32 v[56:57], v[56:57], v[60:61]
    v_mfma_f32_32x32x16_bf16 v[24:39], v[76:79], a[16:19], v[24:39]
    ds_read_b128 v[100:103], v0 offset:39936
    v_pk_add_f32 v[58:59], v[58:59], v[62:63]
    v_pk_add_f32 v[56:57], v[56:57], v[64:65]
    s_waitcnt vmcnt(11) lgkmcnt(4)
    v_mfma_f32_32x32x16_bf16 v[8:23], v[80:83], a[20:23], v[8:23]
    ds_read_b128 v[72:75], v0 offset:8192
    buffer_load_dwordx4 a[68:71], v0, s[4:7], s79 offen offset:1024 sc1
    v_pk_add_f32 v[58:59], v[58:59], v[66:67]
    v_pk_add_f32 v[56:57], v[56:57], v[68:69]
    v_mfma_f32_32x32x16_bf16 v[24:39], v[84:87], a[20:23], v[24:39]
    ds_read_b128 v[76:79], v0 offset:40960
    v_pk_add_f32 v[58:59], v[58:59], v[70:71]
    ds_swizzle_b32 v60, v56 offset:0x101f
    s_waitcnt vmcnt(11) lgkmcnt(5)
    v_mfma_f32_32x32x16_bf16 v[8:23], v[88:91], a[24:27], v[8:23]
    ds_read_b128 v[80:83], v0 offset:9216
    buffer_load_dwordx4 a[72:75], v0, s[4:7], s79 offen offset:2048 sc1
    ds_swizzle_b32 v61, v57 offset:0x101f
    ds_swizzle_b32 v62, v58 offset:0x101f
    v_mfma_f32_32x32x16_bf16 v[24:39], v[92:95], a[24:27], v[24:39]
    ds_read_b128 v[84:87], v0 offset:41984
    ds_swizzle_b32 v63, v59 offset:0x101f
    v_lshrrev_b32 v64, 1, v3
    s_waitcnt vmcnt(11) lgkmcnt(8)
    v_mfma_f32_32x32x16_bf16 v[8:23], v[96:99], a[28:31], v[8:23]
    ds_read_b128 v[88:91], v0 offset:10240
    buffer_load_dwordx4 a[76:79], v0, s[4:7], s79 offen offset:3072 sc1
    v_and_b32 v64, 3, v64
    v_and_b32 v65, 56, v3
    v_mfma_f32_32x32x16_bf16 v[24:39], v[100:103], a[28:31], v[24:39]
    ds_read_b128 v[92:95], v0 offset:43008
    v_or_b32 v64, v64, v65
    v_lshlrev_b32 v64, 2, v64
    s_waitcnt vmcnt(11) lgkmcnt(8)
    v_mfma_f32_32x32x16_bf16 v[8:23], v[72:75], a[32:35], v[8:23]
    ds_read_b128 v[96:99], v0 offset:11264
    s_add_u32 s79, s79, 4096
    buffer_load_dwordx4 a[80:83], v0, s[4:7], s79 offen sc1
    v_and_b32 v65, 1, v3
    v_cmp_eq_u32 vcc, 1, v65
    v_mfma_f32_32x32x16_bf16 v[24:39], v[76:79], a[32:35], v[24:39]
    ds_read_b128 v[100:103], v0 offset:44032
    s_waitcnt lgkmcnt(7)
    v_pk_add_f32 v[56:57], v[56:57], v[60:61]
    s_waitcnt lgkmcnt(4)
    v_pk_add_f32 v[58:59], v[58:59], v[62:63]
    s_waitcnt vmcnt(11)
    v_mfma_f32_32x32x16_bf16 v[8:23], v[80:83], a[36:39], v[8:23]
    ds_read_b128 v[72:75], v0 offset:12288
    buffer_load_dwordx4 a[84:87], v0, s[4:7], s79 offen offset:1024 sc1
    ds_bpermute_b32 v60, v64, v56
    ds_bpermute_b32 v61, v64, v57
    v_mfma_f32_32x32x16_bf16 v[24:39], v[84:87], a[36:39], v[24:39]
    ds_read_b128 v[76:79], v0 offset:45056
    ds_bpermute_b32 v62, v64, v58
    ds_bpermute_b32 v63, v64, v59
    s_waitcnt vmcnt(11) lgkmcnt(8)
    v_mfma_f32_32x32x16_bf16 v[8:23], v[88:91], a[40:43], v[8:23]
    ds_read_b128 v[80:83], v0 offset:13312
    buffer_load_dwordx4 a[88:91], v0, s[4:7], s79 offen offset:2048 sc1
    s_waitcnt lgkmcnt(2)
    v_cndmask_b32 v110, v60, v62, vcc
    s_waitcnt lgkmcnt(1)
    v_cndmask_b32 v111, v61, v63, vcc
    v_mfma_f32_32x32x16_bf16 v[24:39], v[92:95], a[40:43], v[24:39]
    ds_read_b128 v[84:87], v0 offset:46080
    v_mov_b32 v112, v110
    v_mov_b32 v113, v111
    s_waitcnt vmcnt(11)
    v_mfma_f32_32x32x16_bf16 v[8:23], v[96:99], a[44:47], v[8:23]
    ds_read_b128 v[88:91], v0 offset:14336
    buffer_load_dwordx4 a[92:95], v0, s[4:7], s79 offen offset:3072 sc1
    v_permlane32_swap_b32 v110, v112
    v_permlane32_swap_b32 v111, v113
    v_mfma_f32_32x32x16_bf16 v[24:39], v[100:103], a[44:47], v[24:39]
    ds_read_b128 v[92:95], v0 offset:47104
    v_add_f32 v110, v110, v112
    v_add_f32 v111, v111, v113
    s_waitcnt vmcnt(11)
    v_mfma_f32_32x32x16_bf16 v[8:23], v[72:75], a[48:51], v[8:23]
    ds_read_b128 v[96:99], v0 offset:15360
    s_add_u32 s79, s79, 4096
    buffer_load_dwordx4 a[96:99], v0, s[4:7], s79 offen sc1
    v_mul_f32 v108, 0.001953125, v110
    v_mul_f32 v112, v108, v108
    v_mfma_f32_32x32x16_bf16 v[24:39], v[76:79], a[48:51], v[24:39]
    ds_read_b128 v[100:103], v0 offset:48128
    v_mul_f32 v111, 0.001953125, v111
    v_sub_f32 v111, v111, v112
    s_waitcnt vmcnt(11) lgkmcnt(4)
    v_mfma_f32_32x32x16_bf16 v[8:23], v[80:83], a[52:55], v[8:23]
    ds_read_b128 v[72:75], v0 offset:16384
    buffer_load_dwordx4 a[100:103], v0, s[4:7], s79 offen offset:1024 sc1
    v_max_f32 v111, 0, v111
    v_add_f32 v112, 1e-05, v111
    v_mfma_f32_32x32x16_bf16 v[24:39], v[84:87], a[52:55], v[24:39]
    ds_read_b128 v[76:79], v0 offset:49152
    v_rsq_f32 v109, v112
    v_mov_b32 v115, v112
    s_waitcnt vmcnt(11) lgkmcnt(4)
    v_mfma_f32_32x32x16_bf16 v[8:23], v[88:91], a[56:59], v[8:23]
    ds_read_b128 v[80:83], v0 offset:17408
    buffer_load_dwordx4 a[104:107], v0, s[4:7], s79 offen offset:2048 sc1
    v_sub_f32 v110, 0, v108
    v_cvt_pk_bf16_f32 v104, v110, v110
    v_mfma_f32_32x32x16_bf16 v[24:39], v[92:95], a[56:59], v[24:39]
    ds_read_b128 v[84:87], v0 offset:50176
    v_lshlrev_b32 v111, 16, v104
    v_sub_f32 v111, v110, v111
    s_waitcnt vmcnt(11) lgkmcnt(4)
    v_mfma_f32_32x32x16_bf16 v[8:23], v[96:99], a[60:63], v[8:23]
    ds_read_b128 v[88:91], v0 offset:18432
    buffer_load_dwordx4 a[108:111], v0, s[4:7], s79 offen offset:3072 sc1
    v_mov_b32 v106, 0
    v_mov_b32 v107, 0
    v_mfma_f32_32x32x16_bf16 v[24:39], v[100:103], a[60:63], v[24:39]
    ds_read_b128 v[92:95], v0 offset:51200
    v_cvt_pk_bf16_f32 v105, v111, v106
    v_cndmask_b32 v104, v104, v106, s[62:63]
    s_waitcnt vmcnt(11) lgkmcnt(4)
    v_mfma_f32_32x32x16_bf16 v[8:23], v[72:75], a[64:67], v[8:23]
    ds_read_b128 v[96:99], v0 offset:19456
    s_add_u32 s79, s79, 4096
    buffer_load_dwordx4 a[112:115], v0, s[4:7], s79 offen sc1
    v_cndmask_b32 v105, v105, v106, s[62:63]
    v_mul_f32 v114, -1.4426950408889634, v109
    v_mfma_f32_32x32x16_bf16 v[24:39], v[76:79], a[64:67], v[24:39]
    ds_read_b128 v[100:103], v0 offset:52224
    s_waitcnt vmcnt(11) lgkmcnt(4)
    v_mfma_f32_32x32x16_bf16 v[8:23], v[80:83], a[68:71], v[8:23]
    ds_read_b128 v[72:75], v0 offset:20480
    buffer_load_dwordx4 a[116:119], v0, s[4:7], s79 offen offset:1024 sc1
    v_mfma_f32_32x32x16_bf16 v[24:39], v[84:87], a[68:71], v[24:39]
    ds_read_b128 v[76:79], v0 offset:53248
    s_waitcnt vmcnt(11) lgkmcnt(4)
    v_mfma_f32_32x32x16_bf16 v[8:23], v[88:91], a[72:75], v[8:23]
    ds_read_b128 v[80:83], v0 offset:21504
    buffer_load_dwordx4 a[120:123], v0, s[4:7], s79 offen offset:2048 sc1
    v_mfma_f32_32x32x16_bf16 v[24:39], v[92:95], a[72:75], v[24:39]
    ds_read_b128 v[84:87], v0 offset:54272
    s_waitcnt vmcnt(11) lgkmcnt(4)
    v_mfma_f32_32x32x16_bf16 v[8:23], v[96:99], a[76:79], v[8:23]
    ds_read_b128 v[88:91], v0 offset:22528
    buffer_load_dwordx4 a[124:127], v0, s[4:7], s79 offen offset:3072 sc1
    v_mfma_f32_32x32x16_bf16 v[24:39], v[100:103], a[76:79], v[24:39]
    ds_read_b128 v[92:95], v0 offset:55296
    s_waitcnt vmcnt(11) lgkmcnt(4)
    v_mfma_f32_32x32x16_bf16 v[8:23], v[72:75], a[80:83], v[8:23]
    ds_read_b128 v[96:99], v0 offset:23552
    v_mfma_f32_32x32x16_bf16 v[24:39], v[76:79], a[80:83], v[24:39]
    ds_read_b128 v[100:103], v0 offset:56320
    s_waitcnt vmcnt(10) lgkmcnt(4)
    v_mfma_f32_32x32x16_bf16 v[8:23], v[80:83], a[84:87], v[8:23]
    ds_read_b128 v[72:75], v0 offset:24576
    v_mfma_f32_32x32x16_bf16 v[24:39], v[84:87], a[84:87], v[24:39]
    ds_read_b128 v[76:79], v0 offset:57344
    s_waitcnt vmcnt(9) lgkmcnt(4)
    v_mfma_f32_32x32x16_bf16 v[8:23], v[88:91], a[88:91], v[8:23]
    ds_read_b128 v[80:83], v0 offset:25600
    v_mfma_f32_32x32x16_bf16 v[24:39], v[92:95], a[88:91], v[24:39]
    ds_read_b128 v[84:87], v0 offset:58368
    s_waitcnt vmcnt(8) lgkmcnt(4)
    v_mfma_f32_32x32x16_bf16 v[8:23], v[96:99], a[92:95], v[8:23]
    ds_read_b128 v[88:91], v0 offset:26624
    v_mfma_f32_32x32x16_bf16 v[24:39], v[100:103], a[92:95], v[24:39]
    ds_read_b128 v[92:95], v0 offset:59392
    s_waitcnt vmcnt(7) lgkmcnt(4)
    v_mfma_f32_32x32x16_bf16 v[8:23], v[72:75], a[96:99], v[8:23]
    ds_read_b128 v[96:99], v0 offset:27648
    v_mfma_f32_32x32x16_bf16 v[24:39], v[76:79], a[96:99], v[24:39]
    ds_read_b128 v[100:103], v0 offset:60416
    s_waitcnt vmcnt(6) lgkmcnt(4)
    v_mfma_f32_32x32x16_bf16 v[8:23], v[80:83], a[100:103], v[8:23]
    ds_read_b128 v[72:75], v0 offset:28672
    v_mfma_f32_32x32x16_bf16 v[24:39], v[84:87], a[100:103], v[24:39]
    ds_read_b128 v[76:79], v0 offset:61440
    s_waitcnt vmcnt(5) lgkmcnt(4)
    v_mfma_f32_32x32x16_bf16 v[8:23], v[88:91], a[104:107], v[8:23]
    ds_read_b128 v[80:83], v0 offset:29696
    v_mfma_f32_32x32x16_bf16 v[24:39], v[92:95], a[104:107], v[24:39]
    ds_read_b128 v[84:87], v0 offset:62464
    s_waitcnt vmcnt(4) lgkmcnt(4)
    v_mfma_f32_32x32x16_bf16 v[8:23], v[96:99], a[108:111], v[8:23]
    ds_read_b128 v[88:91], v0 offset:30720
    v_mfma_f32_32x32x16_bf16 v[24:39], v[100:103], a[108:111], v[24:39]
    ds_read_b128 v[92:95], v0 offset:63488
    s_waitcnt vmcnt(3) lgkmcnt(4)
    v_mfma_f32_32x32x16_bf16 v[8:23], v[72:75], a[112:115], v[8:23]
    ds_read_b128 v[96:99], v0 offset:31744
    v_mfma_f32_32x32x16_bf16 v[24:39], v[76:79], a[112:115], v[24:39]
    ds_read_b128 v[100:103], v0 offset:64512
    s_waitcnt vmcnt(2) lgkmcnt(4)
    v_mfma_f32_32x32x16_bf16 v[8:23], v[80:83], a[116:119], v[8:23]
    ds_read_b128 v[72:75], v2 offset:22528
    v_mfma_f32_32x32x16_bf16 v[24:39], v[84:87], a[116:119], v[24:39]
    ds_read_b128 v[76:79], v2 offset:23552
    s_waitcnt vmcnt(1) lgkmcnt(4)
    v_mfma_f32_32x32x16_bf16 v[8:23], v[88:91], a[120:123], v[8:23]
    ds_read_b128 v[80:83], v1
    v_mfma_f32_32x32x16_bf16 v[24:39], v[92:95], a[120:123], v[24:39]
    ds_read_b128 v[84:87], v1 offset:1024
    s_waitcnt vmcnt(0) lgkmcnt(4)
    v_mfma_f32_32x32x16_bf16 v[8:23], v[96:99], a[124:127], v[8:23]
    ds_read_b128 v[88:91], v1 offset:2048
    v_mfma_f32_32x32x16_bf16 v[24:39], v[100:103], a[124:127], v[24:39]
    ds_read_b128 v[92:95], v1 offset:3072
    s_waitcnt lgkmcnt(4)
    v_mfma_f32_32x32x16_bf16 v[8:23], v[72:75], v[104:107], v[8:23]
    ds_read_b128 v[96:99], v1 offset:4096
    v_mfma_f32_32x32x16_bf16 v[24:39], v[76:79], v[104:107], v[24:39]
    ds_read_b128 v[100:103], v1 offset:5120
    s_barrier
    s_waitcnt lgkmcnt(4)
    v_mfma_f32_32x32x16_bf16 v[40:55], v[80:83], a[0:3], 0
    ds_read_b128 v[72:75], v1 offset:6144
    s_mul_i32 s23, s17, 7
    s_add_u32 s23, s23, 4
    s_lshl_b32 s23, s23, 15
    s_lshl_b32 s24, s18, 13
    s_add_u32 s23, s23, s24
    s_add_u32 s23, s23, 4194304
    s_add_u32 s24, s24, 0
    s_mov_b32 m0, s24
    s_nop 0
    buffer_load_dwordx4 v0, s[4:7], s23 offen sc1 lds
    v_mfma_f32_32x32x16_bf16 v[40:55], v[84:87], a[4:7], v[40:55]
    ds_read_b128 v[76:79], v1 offset:7168
    v_mul_f32 v116, v8, v114
    v_mul_f32 v117, v9, v114
    v_mul_f32 v118, v10, v114
    v_mul_f32 v119, v11, v114
    v_mul_f32 v120, v12, v114
    s_waitcnt lgkmcnt(4)
    v_mfma_f32_32x32x16_bf16 v[40:55], v[88:91], a[8:11], v[40:55]
    ds_read_b128 v[80:83], v1 offset:8192
    v_mul_f32 v121, v13, v114
    v_mul_f32 v122, v14, v114
    v_mul_f32 v123, v15, v114
    v_exp_f32 v116, v116
    v_mfma_f32_32x32x16_bf16 v[40:55], v[92:95], a[12:15], v[40:55]
    ds_read_b128 v[84:87], v1 offset:9216
    v_exp_f32 v117, v117
    v_exp_f32 v118, v118
    s_waitcnt lgkmcnt(4)
    v_mfma_f32_32x32x16_bf16 v[40:55], v[96:99], a[16:19], v[40:55]
    ds_read_b128 v[88:91], v1 offset:10240
    buffer_load_dwordx4 v0, s[4:7], s23 offen offset:1024 sc1 lds
    v_mfma_f32_32x32x16_bf16 v[40:55], v[100:103], a[20:23], v[40:55]
    ds_read_b128 v[92:95], v1 offset:11264
    v_exp_f32 v119, v119
    v_exp_f32 v120, v120
    s_waitcnt lgkmcnt(4)
    v_mfma_f32_32x32x16_bf16 v[40:55], v[72:75], a[24:27], v[40:55]
    ds_read_b128 v[96:99], v1 offset:12288
    v_exp_f32 v121, v121
    v_exp_f32 v122, v122
    v_mfma_f32_32x32x16_bf16 v[40:55], v[76:79], a[28:31], v[40:55]
    ds_read_b128 v[100:103], v1 offset:13312
    v_exp_f32 v123, v123
    v_mul_f32 v16, v8, v16
    v_mul_f32 v17, v9, v17
    v_mul_f32 v18, v10, v18
    s_waitcnt lgkmcnt(4)
    v_mfma_f32_32x32x16_bf16 v[40:55], v[80:83], a[32:35], v[40:55]
    ds_read_b128 v[72:75], v1 offset:14336
    buffer_load_dwordx4 v0, s[4:7], s23 offen offset:2048 sc1 lds
    v_mul_f32 v19, v11, v19
    v_mfma_f32_32x32x16_bf16 v[40:55], v[84:87], a[36:39], v[40:55]
    ds_read_b128 v[76:79], v1 offset:15360
    v_mul_f32 v20, v12, v20
    v_mul_f32 v21, v13, v21
    v_mul_f32 v22, v14, v22
    v_mul_f32 v23, v15, v23
    v_fma_f32 v116, v116, v115, v115
    s_waitcnt lgkmcnt(4)
    v_mfma_f32_32x32x16_bf16 v[40:55], v[88:91], a[40:43], v[40:55]
    ds_read_b128 v[80:83], v1 offset:16384
    v_fma_f32 v117, v117, v115, v115
    v_fma_f32 v118, v118, v115, v115
    v_fma_f32 v119, v119, v115, v115
    v_fma_f32 v120, v120, v115, v115
    v_fma_f32 v121, v121, v115, v115
    v_mfma_f32_32x32x16_bf16 v[40:55], v[92:95], a[44:47], v[40:55]
    ds_read_b128 v[84:87], v1 offset:17408
    v_fma_f32 v122, v122, v115, v115
    v_fma_f32 v123, v123, v115, v115
    v_rcp_f32 v116, v116
    s_waitcnt lgkmcnt(4)
    v_mfma_f32_32x32x16_bf16 v[40:55], v[96:99], a[48:51], v[40:55]
    ds_read_b128 v[88:91], v1 offset:18432
    buffer_load_dwordx4 v0, s[4:7], s23 offen offset:3072 sc1 lds
    v_mfma_f32_32x32x16_bf16 v[40:55], v[100:103], a[52:55], v[40:55]
    ds_read_b128 v[92:95], v1 offset:19456
    v_rcp_f32 v117, v117
    v_rcp_f32 v118, v118
    s_waitcnt lgkmcnt(4)
    v_mfma_f32_32x32x16_bf16 v[40:55], v[72:75], a[56:59], v[40:55]
    ds_read_b128 v[96:99], v1 offset:20480
    v_rcp_f32 v119, v119
    v_rcp_f32 v120, v120
    v_mfma_f32_32x32x16_bf16 v[40:55], v[76:79], a[60:63], v[40:55]
    ds_read_b128 v[100:103], v1 offset:21504
    v_rcp_f32 v121, v121
    v_rcp_f32 v122, v122
    s_waitcnt lgkmcnt(4)
    v_mfma_f32_32x32x16_bf16 v[40:55], v[80:83], a[64:67], v[40:55]
    ds_read_b128 v[72:75], v1 offset:22528
    s_add_u32 s23, s23, 4096
    s_add_u32 s24, s24, 4096
    s_mov_b32 m0, s24
    s_nop 0
    buffer_load_dwordx4 v0, s[4:7], s23 offen sc1 lds
    v_mfma_f32_32x32x16_bf16 v[40:55], v[84:87], a[68:71], v[40:55]
    ds_read_b128 v[76:79], v1 offset:23552
    v_rcp_f32 v123, v123
    v_mul_f32 v16, v16, v116
    v_mul_f32 v17, v17, v117
    v_mul_f32 v18, v18, v118
    s_waitcnt lgkmcnt(4)
    v_mfma_f32_32x32x16_bf16 v[40:55], v[88:91], a[72:75], v[40:55]
    ds_read_b128 v[80:83], v1 offset:24576
    v_mul_f32 v19, v19, v119
    v_mul_f32 v20, v20, v120
    v_mul_f32 v21, v21, v121
    v_mul_f32 v22, v22, v122
    v_mul_f32 v23, v23, v123
    v_mfma_f32_32x32x16_bf16 v[40:55], v[92:95], a[76:79], v[40:55]
    ds_read_b128 v[84:87], v1 offset:25600
    v_cvt_pk_bf16_f32 v124, v16, v17
    v_cvt_pk_bf16_f32 v125, v18, v19
    v_cvt_pk_bf16_f32 v126, v20, v21
    v_cvt_pk_bf16_f32 v127, v22, v23
    s_waitcnt lgkmcnt(4)
    v_mfma_f32_32x32x16_bf16 v[40:55], v[96:99], a[80:83], v[40:55]
    ds_read_b128 v[88:91], v1 offset:26624
    buffer_load_dwordx4 v0, s[4:7], s23 offen offset:1024 sc1 lds
    v_mfma_f32_32x32x16_bf16 v[40:55], v[100:103], a[84:87], v[40:55]
    ds_read_b128 v[92:95], v1 offset:27648
    buffer_store_dwordx4 v[124:127], v0, s[4:7], s69 offen sc1
    s_waitcnt lgkmcnt(4)
    v_mfma_f32_32x32x16_bf16 v[40:55], v[72:75], a[88:91], v[40:55]
    ds_read_b128 v[96:99], v1 offset:28672
    v_mul_f32 v116, v24, v114
    v_mul_f32 v117, v25, v114
    v_mul_f32 v118, v26, v114
    v_mul_f32 v119, v27, v114
    v_mul_f32 v120, v28, v114
    v_mfma_f32_32x32x16_bf16 v[40:55], v[76:79], a[92:95], v[40:55]
    ds_read_b128 v[100:103], v1 offset:29696
    v_mul_f32 v121, v29, v114
    v_mul_f32 v122, v30, v114
    v_mul_f32 v123, v31, v114
    v_exp_f32 v116, v116
    s_waitcnt lgkmcnt(4)
    v_mfma_f32_32x32x16_bf16 v[40:55], v[80:83], a[96:99], v[40:55]
    ds_read_b128 v[72:75], v1 offset:30720
    buffer_load_dwordx4 v0, s[4:7], s23 offen offset:2048 sc1 lds
    v_mfma_f32_32x32x16_bf16 v[40:55], v[84:87], a[100:103], v[40:55]
    ds_read_b128 v[76:79], v1 offset:31744
    v_exp_f32 v117, v117
    v_exp_f32 v118, v118
    s_waitcnt lgkmcnt(4)
    v_mfma_f32_32x32x16_bf16 v[40:55], v[88:91], a[104:107], v[40:55]
    ds_read_b128 v[80:83], v2 offset:24576
    v_exp_f32 v119, v119
    v_exp_f32 v120, v120
    v_mfma_f32_32x32x16_bf16 v[40:55], v[92:95], a[108:111], v[40:55]
    ds_read_b128 v[84:87], v1 offset:32768
    v_exp_f32 v121, v121
    v_exp_f32 v122, v122
    s_waitcnt lgkmcnt(4)
    v_mfma_f32_32x32x16_bf16 v[40:55], v[96:99], a[112:115], v[40:55]
    ds_read_b128 v[88:91], v1 offset:33792
    buffer_load_dwordx4 v0, s[4:7], s23 offen offset:3072 sc1 lds
    v_mfma_f32_32x32x16_bf16 v[40:55], v[100:103], a[116:119], v[40:55]
    ds_read_b128 v[92:95], v1 offset:34816
    v_exp_f32 v123, v123
    v_mul_f32 v32, v24, v32
    v_mul_f32 v33, v25, v33
    v_mul_f32 v34, v26, v34
    s_waitcnt lgkmcnt(4)
    v_mfma_f32_32x32x16_bf16 v[40:55], v[72:75], a[120:123], v[40:55]
    ds_read_b128 v[96:99], v1 offset:35840
    v_mul_f32 v35, v27, v35
    v_mul_f32 v36, v28, v36
    v_mul_f32 v37, v29, v37
    v_mul_f32 v38, v30, v38
    v_mul_f32 v39, v31, v39
    v_mfma_f32_32x32x16_bf16 v[40:55], v[76:79], a[124:127], v[40:55]
    ds_read_b128 v[100:103], v1 offset:36864
    v_fma_f32 v116, v116, v115, v115
    v_fma_f32 v117, v117, v115, v115
    v_fma_f32 v118, v118, v115, v115
    v_fma_f32 v119, v119, v115, v115
    v_fma_f32 v120, v120, v115, v115
    s_waitcnt lgkmcnt(4)
    v_mfma_f32_32x32x16_bf16 v[40:55], v[80:83], v[104:107], v[40:55]
    ds_read_b128 v[72:75], v1 offset:37888
    v_fma_f32 v121, v121, v115, v115
    v_fma_f32 v122, v122, v115, v115
    v_fma_f32 v123, v123, v115, v115
    v_rcp_f32 v116, v116
    v_mfma_f32_32x32x16_bf16 v[8:23], v[84:87], a[0:3], 0
    ds_read_b128 v[76:79], v1 offset:38912
    s_mul_i32 s26, s17, 7
    s_add_u32 s26, s26, 5
    s_lshl_b32 s26, s26, 15
    s_lshl_b32 s27, s18, 13
    s_add_u32 s26, s26, s27
    s_add_u32 s26, s26, 4194304
    s_add_u32 s27, s27, 32768
    s_mov_b32 m0, s27
    s_nop 0
    buffer_load_dwordx4 v0, s[4:7], s26 offen sc1 lds
    s_waitcnt lgkmcnt(4)
    v_mfma_f32_32x32x16_bf16 v[8:23], v[88:91], a[4:7], v[8:23]
    ds_read_b128 v[80:83], v1 offset:39936
    v_rcp_f32 v117, v117
    v_rcp_f32 v118, v118
    v_mfma_f32_32x32x16_bf16 v[8:23], v[92:95], a[8:11], v[8:23]
    ds_read_b128 v[84:87], v1 offset:40960
    v_rcp_f32 v119, v119
    v_rcp_f32 v120, v120
    s_waitcnt lgkmcnt(4)
    v_mfma_f32_32x32x16_bf16 v[8:23], v[96:99], a[12:15], v[8:23]
    ds_read_b128 v[88:91], v1 offset:41984
    v_rcp_f32 v121, v121
    v_rcp_f32 v122, v122
    v_mfma_f32_32x32x16_bf16 v[8:23], v[100:103], a[16:19], v[8:23]
    ds_read_b128 v[92:95], v1 offset:43008
    buffer_load_dwordx4 v0, s[4:7], s26 offen offset:1024 sc1 lds
    s_waitcnt lgkmcnt(4)
    v_mfma_f32_32x32x16_bf16 v[8:23], v[72:75], a[20:23], v[8:23]
    ds_read_b128 v[96:99], v1 offset:44032
    v_rcp_f32 v123, v123
    v_mul_f32 v32, v32, v116
    v_mul_f32 v33, v33, v117
    v_mul_f32 v34, v34, v118
    v_mfma_f32_32x32x16_bf16 v[8:23], v[76:79], a[24:27], v[8:23]
    ds_read_b128 v[100:103], v1 offset:45056
    v_mul_f32 v35, v35, v119
    v_mul_f32 v36, v36, v120
    v_mul_f32 v37, v37, v121
    v_mul_f32 v38, v38, v122
    v_mul_f32 v39, v39, v123
    s_waitcnt lgkmcnt(4)
    v_mfma_f32_32x32x16_bf16 v[8:23], v[80:83], a[28:31], v[8:23]
    ds_read_b128 v[72:75], v1 offset:46080
    buffer_load_dwordx4 v0, s[4:7], s26 offen offset:2048 sc1 lds
    v_cvt_pk_bf16_f32 v124, v32, v33
    v_mfma_f32_32x32x16_bf16 v[8:23], v[84:87], a[32:35], v[8:23]
    ds_read_b128 v[76:79], v1 offset:47104
    v_cvt_pk_bf16_f32 v125, v34, v35
    v_cvt_pk_bf16_f32 v126, v36, v37
    v_cvt_pk_bf16_f32 v127, v38, v39
    s_waitcnt lgkmcnt(4)
    v_mfma_f32_32x32x16_bf16 v[8:23], v[88:91], a[36:39], v[8:23]
    ds_read_b128 v[80:83], v1 offset:48128
    buffer_store_dwordx4 v[124:127], v0, s[4:7], s69 offen offset:1024 sc1
    v_mfma_f32_32x32x16_bf16 v[8:23], v[92:95], a[40:43], v[8:23]
    ds_read_b128 v[84:87], v1 offset:49152
    v_mul_f32 v116, v40, v114
    v_mul_f32 v117, v41, v114
    v_mul_f32 v118, v42, v114
    v_mul_f32 v119, v43, v114
    v_mul_f32 v120, v44, v114
    s_waitcnt lgkmcnt(4)
    v_mfma_f32_32x32x16_bf16 v[8:23], v[96:99], a[44:47], v[8:23]
    ds_read_b128 v[88:91], v1 offset:50176
    buffer_load_dwordx4 v0, s[4:7], s26 offen offset:3072 sc1 lds
    v_mul_f32 v121, v45, v114
    v_mfma_f32_32x32x16_bf16 v[8:23], v[100:103], a[48:51], v[8:23]
    ds_read_b128 v[92:95], v1 offset:51200
    v_mul_f32 v122, v46, v114
    v_mul_f32 v123, v47, v114
    v_exp_f32 v116, v116
    s_waitcnt lgkmcnt(4)
    v_mfma_f32_32x32x16_bf16 v[8:23], v[72:75], a[52:55], v[8:23]
    ds_read_b128 v[96:99], v1 offset:52224
    v_exp_f32 v117, v117
    v_exp_f32 v118, v118
    v_mfma_f32_32x32x16_bf16 v[8:23], v[76:79], a[56:59], v[8:23]
    ds_read_b128 v[100:103], v1 offset:53248
    s_add_u32 s26, s26, 4096
    s_add_u32 s27, s27, 4096
    s_mov_b32 m0, s27
    s_nop 0
    buffer_load_dwordx4 v0, s[4:7], s26 offen sc1 lds
    s_waitcnt lgkmcnt(4)
    v_mfma_f32_32x32x16_bf16 v[8:23], v[80:83], a[60:63], v[8:23]
    ds_read_b128 v[72:75], v1 offset:54272
    v_exp_f32 v119, v119
    v_exp_f32 v120, v120
    v_mfma_f32_32x32x16_bf16 v[8:23], v[84:87], a[64:67], v[8:23]
    ds_read_b128 v[76:79], v1 offset:55296
    v_exp_f32 v121, v121
    v_exp_f32 v122, v122
    s_waitcnt lgkmcnt(4)
    v_mfma_f32_32x32x16_bf16 v[8:23], v[88:91], a[68:71], v[8:23]
    ds_read_b128 v[80:83], v1 offset:56320
    v_exp_f32 v123, v123
    v_mul_f32 v48, v40, v48
    v_mul_f32 v49, v41, v49
    v_mul_f32 v50, v42, v50
    v_mfma_f32_32x32x16_bf16 v[8:23], v[92:95], a[72:75], v[8:23]
    ds_read_b128 v[84:87], v1 offset:57344
    buffer_load_dwordx4 v0, s[4:7], s26 offen offset:1024 sc1 lds
    v_mul_f32 v51, v43, v51
    s_waitcnt lgkmcnt(4)
    v_mfma_f32_32x32x16_bf16 v[8:23], v[96:99], a[76:79], v[8:23]
    ds_read_b128 v[88:91], v1 offset:58368
    v_mul_f32 v52, v44, v52
    v_mul_f32 v53, v45, v53
    v_mul_f32 v54, v46, v54
    v_mul_f32 v55, v47, v55
    v_fma_f32 v116, v116, v115, v115
    v_mfma_f32_32x32x16_bf16 v[8:23], v[100:103], a[80:83], v[8:23]
    ds_read_b128 v[92:95], v1 offset:59392
    v_fma_f32 v117, v117, v115, v115
    v_fma_f32 v118, v118, v115, v115
    v_fma_f32 v119, v119, v115, v115
    v_fma_f32 v120, v120, v115, v115
    v_fma_f32 v121, v121, v115, v115
    s_waitcnt lgkmcnt(4)
    v_mfma_f32_32x32x16_bf16 v[8:23], v[72:75], a[84:87], v[8:23]
    ds_read_b128 v[96:99], v1 offset:60416
    buffer_load_dwordx4 v0, s[4:7], s26 offen offset:2048 sc1 lds
    v_fma_f32 v122, v122, v115, v115
    v_mfma_f32_32x32x16_bf16 v[8:23], v[76:79], a[88:91], v[8:23]
    ds_read_b128 v[100:103], v1 offset:61440
    v_fma_f32 v123, v123, v115, v115
    v_rcp_f32 v116, v116
    v_rcp_f32 v117, v117
    s_waitcnt lgkmcnt(4)
    v_mfma_f32_32x32x16_bf16 v[8:23], v[80:83], a[92:95], v[8:23]
    ds_read_b128 v[72:75], v1 offset:62464
    v_rcp_f32 v118, v118
    v_rcp_f32 v119, v119
    v_mfma_f32_32x32x16_bf16 v[8:23], v[84:87], a[96:99], v[8:23]
    ds_read_b128 v[76:79], v1 offset:63488
    v_rcp_f32 v120, v120
    v_rcp_f32 v121, v121
    s_waitcnt lgkmcnt(4)
    v_mfma_f32_32x32x16_bf16 v[8:23], v[88:91], a[100:103], v[8:23]
    ds_read_b128 v[80:83], v1 offset:64512
    buffer_load_dwordx4 v0, s[4:7], s26 offen offset:3072 sc1 lds
    v_mfma_f32_32x32x16_bf16 v[8:23], v[92:95], a[104:107], v[8:23]
    ds_read_b128 v[84:87], v2 offset:25600
    s_waitcnt vmcnt(9)
    s_barrier
    v_rcp_f32 v122, v122
    v_rcp_f32 v123, v123
    v_mul_f32 v48, v48, v116
    s_waitcnt lgkmcnt(4)
    v_mfma_f32_32x32x16_bf16 v[8:23], v[96:99], a[108:111], v[8:23]
    ds_read_b128 v[88:91], v0
    v_mul_f32 v49, v49, v117
    v_mul_f32 v50, v50, v118
    v_mul_f32 v51, v51, v119
    v_mul_f32 v52, v52, v120
    v_mul_f32 v53, v53, v121
    v_mfma_f32_32x32x16_bf16 v[8:23], v[100:103], a[112:115], v[8:23]
    ds_read_b128 v[92:95], v0 offset:1024
    v_mul_f32 v54, v54, v122
    v_mul_f32 v55, v55, v123
    v_cvt_pk_bf16_f32 v124, v48, v49
    v_cvt_pk_bf16_f32 v125, v50, v51
    v_cvt_pk_bf16_f32 v126, v52, v53
    s_waitcnt lgkmcnt(4)
    v_mfma_f32_32x32x16_bf16 v[8:23], v[72:75], a[116:119], v[8:23]
    ds_read_b128 v[96:99], v0 offset:2048
    v_cvt_pk_bf16_f32 v127, v54, v55
    v_mfma_f32_32x32x16_bf16 v[8:23], v[76:79], a[120:123], v[8:23]
    ds_read_b128 v[100:103], v0 offset:3072
    buffer_store_dwordx4 v[124:127], v0, s[4:7], s69 offen offset:2048 sc1
    s_waitcnt lgkmcnt(4)
    v_mfma_f32_32x32x16_bf16 v[8:23], v[80:83], a[124:127], v[8:23]
    ds_read_b128 v[72:75], v0 offset:4096
    v_mfma_f32_32x32x16_bf16 v[8:23], v[84:87], v[104:107], v[8:23]
    ds_read_b128 v[76:79], v0 offset:5120
    s_waitcnt lgkmcnt(4)
    v_mfma_f32_32x32x16_bf16 v[24:39], v[88:91], a[0:3], 0
    ds_read_b128 v[80:83], v0 offset:6144
    s_mul_i32 s23, s17, 7
    s_add_u32 s23, s23, 6
    s_lshl_b32 s23, s23, 15
    s_lshl_b32 s24, s18, 13
    s_add_u32 s23, s23, s24
    s_add_u32 s23, s23, 4194304
    s_add_u32 s24, s24, 65536
    s_mov_b32 m0, s24
    s_nop 0
    buffer_load_dwordx4 v0, s[4:7], s23 offen sc1 lds
    v_mfma_f32_32x32x16_bf16 v[24:39], v[92:95], a[4:7], v[24:39]
    ds_read_b128 v[84:87], v0 offset:7168
    v_mul_f32 v116, v8, v114
    v_mul_f32 v117, v9, v114
    v_mul_f32 v118, v10, v114
    v_mul_f32 v119, v11, v114
    v_mul_f32 v120, v12, v114
    s_waitcnt lgkmcnt(4)
    v_mfma_f32_32x32x16_bf16 v[24:39], v[96:99], a[8:11], v[24:39]
    ds_read_b128 v[88:91], v0 offset:8192
    v_mul_f32 v121, v13, v114
    v_mul_f32 v122, v14, v114
    v_mul_f32 v123, v15, v114
    v_exp_f32 v116, v116
    v_mfma_f32_32x32x16_bf16 v[24:39], v[100:103], a[12:15], v[24:39]
    ds_read_b128 v[92:95], v0 offset:9216
    buffer_load_dwordx4 v0, s[4:7], s23 offen offset:1024 sc1 lds
    s_waitcnt lgkmcnt(4)
    v_mfma_f32_32x32x16_bf16 v[24:39], v[72:75], a[16:19], v[24:39]
    ds_read_b128 v[96:99], v0 offset:10240
    v_exp_f32 v117, v117
    v_exp_f32 v118, v118
    v_mfma_f32_32x32x16_bf16 v[24:39], v[76:79], a[20:23], v[24:39]
    ds_read_b128 v[100:103], v0 offset:11264
    v_exp_f32 v119, v119
    v_exp_f32 v120, v120
    s_waitcnt lgkmcnt(4)
    v_mfma_f32_32x32x16_bf16 v[24:39], v[80:83], a[24:27], v[24:39]
    ds_read_b128 v[72:75], v0 offset:12288
    buffer_load_dwordx4 v0, s[4:7], s23 offen offset:2048 sc1 lds
    v_mfma_f32_32x32x16_bf16 v[24:39], v[84:87], a[28:31], v[24:39]
    ds_read_b128 v[76:79], v0 offset:13312
    v_exp_f32 v121, v121
    v_exp_f32 v122, v122
    s_waitcnt lgkmcnt(4)
    v_mfma_f32_32x32x16_bf16 v[24:39], v[88:91], a[32:35], v[24:39]
    ds_read_b128 v[80:83], v0 offset:14336
    buffer_load_dwordx4 v0, s[4:7], s23 offen offset:3072 sc1 lds
    v_mfma_f32_32x32x16_bf16 v[24:39], v[92:95], a[36:39], v[24:39]
    ds_read_b128 v[84:87], v0 offset:15360
    v_exp_f32 v123, v123
    v_mul_f32 v16, v8, v16
    v_mul_f32 v17, v9, v17
    v_mul_f32 v18, v10, v18
    s_waitcnt lgkmcnt(4)
    v_mfma_f32_32x32x16_bf16 v[24:39], v[96:99], a[40:43], v[24:39]
    ds_read_b128 v[88:91], v0 offset:16384
    v_mul_f32 v19, v11, v19
    v_mul_f32 v20, v12, v20
    v_mul_f32 v21, v13, v21
    v_mul_f32 v22, v14, v22
    v_mul_f32 v23, v15, v23
    v_mfma_f32_32x32x16_bf16 v[24:39], v[100:103], a[44:47], v[24:39]
    ds_read_b128 v[92:95], v0 offset:17408
    s_add_u32 s23, s23, 4096
    s_add_u32 s24, s24, 4096
    s_mov_b32 m0, s24
    s_nop 0
    buffer_load_dwordx4 v0, s[4:7], s23 offen sc1 lds
    s_waitcnt lgkmcnt(4)
    v_mfma_f32_32x32x16_bf16 v[24:39], v[72:75], a[48:51], v[24:39]
    ds_read_b128 v[96:99], v0 offset:18432
    v_fma_f32 v116, v116, v115, v115
    v_fma_f32 v117, v117, v115, v115
    v_fma_f32 v118, v118, v115, v115
    v_fma_f32 v119, v119, v115, v115
    v_fma_f32 v120, v120, v115, v115
    v_mfma_f32_32x32x16_bf16 v[24:39], v[76:79], a[52:55], v[24:39]
    ds_read_b128 v[100:103], v0 offset:19456
    buffer_load_dwordx4 v0, s[4:7], s23 offen offset:1024 sc1 lds
    v_fma_f32 v121, v121, v115, v115
    s_waitcnt lgkmcnt(4)
    v_mfma_f32_32x32x16_bf16 v[24:39], v[80:83], a[56:59], v[24:39]
    ds_read_b128 v[72:75], v0 offset:20480
    v_fma_f32 v122, v122, v115, v115
    v_fma_f32 v123, v123, v115, v115
    v_rcp_f32 v116, v116
    v_mfma_f32_32x32x16_bf16 v[24:39], v[84:87], a[60:63], v[24:39]
    ds_read_b128 v[76:79], v0 offset:21504
    v_rcp_f32 v117, v117
    v_rcp_f32 v118, v118
    s_waitcnt lgkmcnt(4)
    v_mfma_f32_32x32x16_bf16 v[24:39], v[88:91], a[64:67], v[24:39]
    ds_read_b128 v[80:83], v0 offset:22528
    buffer_load_dwordx4 v0, s[4:7], s23 offen offset:2048 sc1 lds
    v_mfma_f32_32x32x16_bf16 v[24:39], v[92:95], a[68:71], v[24:39]
    ds_read_b128 v[84:87], v0 offset:23552
    v_rcp_f32 v119, v119
    v_rcp_f32 v120, v120
    s_waitcnt lgkmcnt(4)
    v_mfma_f32_32x32x16_bf16 v[24:39], v[96:99], a[72:75], v[24:39]
    ds_read_b128 v[88:91], v0 offset:24576
    v_rcp_f32 v121, v121
    v_rcp_f32 v122, v122
    v_mfma_f32_32x32x16_bf16 v[24:39], v[100:103], a[76:79], v[24:39]
    ds_read_b128 v[92:95], v0 offset:25600
    buffer_load_dwordx4 v0, s[4:7], s23 offen offset:3072 sc1 lds
    s_waitcnt lgkmcnt(4)
    v_mfma_f32_32x32x16_bf16 v[24:39], v[72:75], a[80:83], v[24:39]
    ds_read_b128 v[96:99], v0 offset:26624
    v_rcp_f32 v123, v123
    v_mul_f32 v16, v16, v116
    v_mul_f32 v17, v17, v117
    v_mul_f32 v18, v18, v118
    v_mfma_f32_32x32x16_bf16 v[24:39], v[76:79], a[84:87], v[24:39]
    ds_read_b128 v[100:103], v0 offset:27648
    buffer_load_dwordx4 a[136:139], v0, s[4:7], s70 offen offset:2048 sc1
    v_mul_f32 v19, v19, v119
    s_waitcnt lgkmcnt(4)
    v_mfma_f32_32x32x16_bf16 v[24:39], v[80:83], a[88:91], v[24:39]
    ds_read_b128 v[72:75], v0 offset:28672
    v_mul_f32 v20, v20, v120
    v_mul_f32 v21, v21, v121
    v_mul_f32 v22, v22, v122
    v_mul_f32 v23, v23, v123
    v_cvt_pk_bf16_f32 v124, v16, v17
    v_mfma_f32_32x32x16_bf16 v[24:39], v[84:87], a[92:95], v[24:39]
    ds_read_b128 v[76:79], v0 offset:29696
    v_cvt_pk_bf16_f32 v125, v18, v19
    v_cvt_pk_bf16_f32 v126, v20, v21
    v_cvt_pk_bf16_f32 v127, v22, v23
    s_waitcnt lgkmcnt(4)
    v_mfma_f32_32x32x16_bf16 v[24:39], v[88:91], a[96:99], v[24:39]
    ds_read_b128 v[80:83], v0 offset:30720
    buffer_load_dwordx4 a[140:143], v0, s[4:7], s70 offen offset:3072 sc1
    v_mfma_f32_32x32x16_bf16 v[24:39], v[92:95], a[100:103], v[24:39]
    ds_read_b128 v[84:87], v0 offset:31744
    buffer_store_dwordx4 v[124:127], v0, s[4:7], s69 offen offset:3072 sc1
    s_waitcnt lgkmcnt(4)
    v_mfma_f32_32x32x16_bf16 v[24:39], v[96:99], a[104:107], v[24:39]
    ds_read_b128 v[88:91], v2 offset:26624
    s_waitcnt vmcnt(11)
    s_barrier
    s_cmp_eq_u32 s18, 0
    s_cbranch_scc0 L_skip_62
    s_mov_b64 exec, 1
    buffer_atomic_add v4, off, s[4:7], s84
    s_mov_b64 exec, -1
L_skip_62:
    s_add_u32 s70, s70, 7168
    buffer_load_dwordx4 a[144:147], v0, s[4:7], s70 offen sc1
    v_mfma_f32_32x32x16_bf16 v[24:39], v[100:103], a[108:111], v[24:39]
    ds_read_b128 v[92:95], v0 offset:32768
    s_waitcnt lgkmcnt(4)
    v_mfma_f32_32x32x16_bf16 v[24:39], v[72:75], a[112:115], v[24:39]
    ds_read_b128 v[96:99], v0 offset:33792
    v_mfma_f32_32x32x16_bf16 v[24:39], v[76:79], a[116:119], v[24:39]
    ds_read_b128 v[100:103], v0 offset:34816
    buffer_load_dwordx4 a[148:151], v0, s[4:7], s70 offen offset:1024 sc1
    s_waitcnt lgkmcnt(4)
    v_mfma_f32_32x32x16_bf16 v[24:39], v[80:83], a[120:123], v[24:39]
    ds_read_b128 v[72:75], v0 offset:35840
    v_mfma_f32_32x32x16_bf16 v[24:39], v[84:87], a[124:127], v[24:39]
    ds_read_b128 v[76:79], v0 offset:36864
    s_waitcnt lgkmcnt(4)
    v_mfma_f32_32x32x16_bf16 v[24:39], v[88:91], v[104:107], v[24:39]
    ds_read_b128 v[80:83], v0 offset:37888
    v_mfma_f32_32x32x16_bf16 v[40:55], v[92:95], a[0:3], 0
    ds_read_b128 v[84:87], v0 offset:38912
    buffer_load_dwordx4 a[152:155], v0, s[4:7], s70 offen offset:2048 sc1
    s_waitcnt lgkmcnt(4)
    v_mfma_f32_32x32x16_bf16 v[40:55], v[96:99], a[4:7], v[40:55]
    ds_read_b128 v[88:91], v0 offset:39936
    s_nop 4
    v_mul_f32 v116, v24, v114
    v_mul_f32 v117, v25, v114
    v_mul_f32 v118, v26, v114
    v_mul_f32 v119, v27, v114
    v_mul_f32 v120, v28, v114
    v_mfma_f32_32x32x16_bf16 v[40:55], v[100:103], a[8:11], v[40:55]
    ds_read_b128 v[92:95], v0 offset:40960
    v_mul_f32 v121, v29, v114
    v_mul_f32 v122, v30, v114
    v_mul_f32 v123, v31, v114
    v_exp_f32 v116, v116
    s_waitcnt lgkmcnt(4)
    v_mfma_f32_32x32x16_bf16 v[40:55], v[72:75], a[12:15], v[40:55]
    ds_read_b128 v[96:99], v0 offset:41984
    buffer_load_dwordx4 a[156:159], v0, s[4:7], s70 offen offset:3072 sc1
    v_mfma_f32_32x32x16_bf16 v[40:55], v[76:79], a[16:19], v[40:55]
    ds_read_b128 v[100:103], v0 offset:43008
    v_exp_f32 v117, v117
    v_exp_f32 v118, v118
    s_waitcnt lgkmcnt(4)
    v_mfma_f32_32x32x16_bf16 v[40:55], v[80:83], a[20:23], v[40:55]
    ds_read_b128 v[72:75], v0 offset:44032
    v_exp_f32 v119, v119
    v_exp_f32 v120, v120
    v_mfma_f32_32x32x16_bf16 v[40:55], v[84:87], a[24:27], v[40:55]
    ds_read_b128 v[76:79], v0 offset:45056
    s_add_u32 s70, s70, 7168
    buffer_load_dwordx4 a[160:163], v0, s[4:7], s70 offen sc1
    s_waitcnt lgkmcnt(4)
    v_mfma_f32_32x32x16_bf16 v[40:55], v[88:91], a[28:31], v[40:55]
    ds_read_b128 v[80:83], v0 offset:46080
    v_exp_f32 v121, v121
    v_exp_f32 v122, v122
    v_mfma_f32_32x32x16_bf16 v[40:55], v[92:95], a[32:35], v[40:55]
    ds_read_b128 v[84:87], v0 offset:47104
    v_exp_f32 v123, v123
    v_mul_f32 v32, v24, v32
    v_mul_f32 v33, v25, v33
    v_mul_f32 v34, v26, v34
    s_waitcnt lgkmcnt(4)
    v_mfma_f32_32x32x16_bf16 v[40:55], v[96:99], a[36:39], v[40:55]
    ds_read_b128 v[88:91], v0 offset:48128
    buffer_load_dwordx4 a[164:167], v0, s[4:7], s70 offen offset:1024 sc1
    v_mul_f32 v35, v27, v35
    v_mfma_f32_32x32x16_bf16 v[40:55], v[100:103], a[40:43], v[40:55]
    ds_read_b128 v[92:95], v0 offset:49152
    v_mul_f32 v36, v28, v36
    v_mul_f32 v37, v29, v37
    v_mul_f32 v38, v30, v38
    v_mul_f32 v39, v31, v39
    v_fma_f32 v116, v116, v115, v115
    s_waitcnt lgkmcnt(4)
    v_mfma_f32_32x32x16_bf16 v[40:55], v[72:75], a[44:47], v[40:55]
    ds_read_b128 v[96:99], v0 offset:50176
    v_fma_f32 v117, v117, v115, v115
    v_fma_f32 v118, v118, v115, v115
    v_fma_f32 v119, v119, v115, v115
    v_fma_f32 v120, v120, v115, v115
    v_fma_f32 v121, v121, v115, v115
    v_mfma_f32_32x32x16_bf16 v[40:55], v[76:79], a[48:51], v[40:55]
    ds_read_b128 v[100:103], v0 offset:51200
    buffer_load_dwordx4 a[168:171], v0, s[4:7], s70 offen offset:2048 sc1
    v_fma_f32 v122, v122, v115, v115
    s_waitcnt lgkmcnt(4)
    v_mfma_f32_32x32x16_bf16 v[40:55], v[80:83], a[52:55], v[40:55]
    ds_read_b128 v[72:75], v0 offset:52224
    v_fma_f32 v123, v123, v115, v115
    v_rcp_f32 v116, v116
    v_rcp_f32 v117, v117
    v_mfma_f32_32x32x16_bf16 v[40:55], v[84:87], a[56:59], v[40:55]
    ds_read_b128 v[76:79], v0 offset:53248
    v_rcp_f32 v118, v118
    v_rcp_f32 v119, v119
    s_waitcnt lgkmcnt(4)
    v_mfma_f32_32x32x16_bf16 v[40:55], v[88:91], a[60:63], v[40:55]
    ds_read_b128 v[80:83], v0 offset:54272
    buffer_load_dwordx4 a[172:175], v0, s[4:7], s70 offen offset:3072 sc1
    v_mfma_f32_32x32x16_bf16 v[40:55], v[92:95], a[64:67], v[40:55]
    ds_read_b128 v[84:87], v0 offset:55296
    v_rcp_f32 v120, v120
    v_rcp_f32 v121, v121
    s_waitcnt lgkmcnt(4)
    v_mfma_f32_32x32x16_bf16 v[40:55], v[96:99], a[68:71], v[40:55]
    ds_read_b128 v[88:91], v0 offset:56320
    v_rcp_f32 v122, v122
    v_rcp_f32 v123, v123
    v_mul_f32 v32, v32, v116
    v_mfma_f32_32x32x16_bf16 v[40:55], v[100:103], a[72:75], v[40:55]
    ds_read_b128 v[92:95], v0 offset:57344
    s_add_u32 s70, s70, 7168
    buffer_load_dwordx4 a[176:179], v0, s[4:7], s70 offen sc1
    v_mul_f32 v33, v33, v117
    s_waitcnt lgkmcnt(4)
    v_mfma_f32_32x32x16_bf16 v[40:55], v[72:75], a[76:79], v[40:55]
    ds_read_b128 v[96:99], v0 offset:58368
    v_mul_f32 v34, v34, v118
    v_mul_f32 v35, v35, v119
    v_mul_f32 v36, v36, v120
    v_mul_f32 v37, v37, v121
    v_mul_f32 v38, v38, v122
    v_mfma_f32_32x32x16_bf16 v[40:55], v[76:79], a[80:83], v[40:55]
    ds_read_b128 v[100:103], v0 offset:59392
    v_mul_f32 v39, v39, v123
    v_cvt_pk_bf16_f32 v124, v32, v33
    v_cvt_pk_bf16_f32 v125, v34, v35
    v_cvt_pk_bf16_f32 v126, v36, v37
    v_cvt_pk_bf16_f32 v127, v38, v39
    s_add_u32 s69, s69, 4096
    s_waitcnt lgkmcnt(4)
    v_mfma_f32_32x32x16_bf16 v[40:55], v[80:83], a[84:87], v[40:55]
    ds_read_b128 v[72:75], v0 offset:60416
    buffer_load_dwordx4 a[180:183], v0, s[4:7], s70 offen offset:1024 sc1
    v_mfma_f32_32x32x16_bf16 v[40:55], v[84:87], a[88:91], v[40:55]
    ds_read_b128 v[76:79], v0 offset:61440
    buffer_store_dwordx4 v[124:127], v0, s[4:7], s69 offen sc1
    s_waitcnt lgkmcnt(4)
    v_mfma_f32_32x32x16_bf16 v[40:55], v[88:91], a[92:95], v[40:55]
    ds_read_b128 v[80:83], v0 offset:62464
    v_mfma_f32_32x32x16_bf16 v[40:55], v[92:95], a[96:99], v[40:55]
    ds_read_b128 v[84:87], v0 offset:63488
    buffer_load_dwordx4 a[184:187], v0, s[4:7], s70 offen offset:2048 sc1
    s_waitcnt lgkmcnt(4)
    v_mfma_f32_32x32x16_bf16 v[40:55], v[96:99], a[100:103], v[40:55]
    ds_read_b128 v[88:91], v0 offset:64512
    v_mfma_f32_32x32x16_bf16 v[40:55], v[100:103], a[104:107], v[40:55]
    ds_read_b128 v[92:95], v2 offset:27648
    s_waitcnt vmcnt(15)
    s_barrier
    s_waitcnt lgkmcnt(4)
    v_mfma_f32_32x32x16_bf16 v[40:55], v[72:75], a[108:111], v[40:55]
    ds_read_b128 v[96:99], v1
    buffer_load_dwordx4 a[188:191], v0, s[4:7], s70 offen offset:3072 sc1
    v_mfma_f32_32x32x16_bf16 v[40:55], v[76:79], a[112:115], v[40:55]
    ds_read_b128 v[100:103], v1 offset:1024
    s_waitcnt lgkmcnt(4)
    v_mfma_f32_32x32x16_bf16 v[40:55], v[80:83], a[116:119], v[40:55]
    ds_read_b128 v[72:75], v1 offset:2048
    v_mfma_f32_32x32x16_bf16 v[40:55], v[84:87], a[120:123], v[40:55]
    ds_read_b128 v[76:79], v1 offset:3072
    s_waitcnt lgkmcnt(4)
    v_mfma_f32_32x32x16_bf16 v[40:55], v[88:91], a[124:127], v[40:55]
    ds_read_b128 v[80:83], v1 offset:4096
    v_mfma_f32_32x32x16_bf16 v[40:55], v[92:95], v[104:107], v[40:55]
    ds_read_b128 v[84:87], v1 offset:5120
    s_waitcnt lgkmcnt(4)
    v_mfma_f32_32x32x16_bf16 v[8:23], v[96:99], a[0:3], 0
    ds_read_b128 v[88:91], v1 offset:6144
    v_mfma_f32_32x32x16_bf16 v[8:23], v[100:103], a[4:7], v[8:23]
    ds_read_b128 v[92:95], v1 offset:7168
    s_nop 5
    v_mul_f32 v116, v40, v114
    v_mul_f32 v117, v41, v114
    v_mul_f32 v118, v42, v114
    v_mul_f32 v119, v43, v114
    v_mul_f32 v120, v44, v114
    s_waitcnt lgkmcnt(4)
    v_mfma_f32_32x32x16_bf16 v[8:23], v[72:75], a[8:11], v[8:23]
    ds_read_b128 v[96:99], v1 offset:8192
    v_mul_f32 v121, v45, v114
    v_mul_f32 v122, v46, v114
    v_mul_f32 v123, v47, v114
    v_exp_f32 v116, v116
    v_mfma_f32_32x32x16_bf16 v[8:23], v[76:79], a[12:15], v[8:23]
    ds_read_b128 v[100:103], v1 offset:9216
    v_exp_f32 v117, v117
    v_exp_f32 v118, v118
    s_waitcnt lgkmcnt(4)
    v_mfma_f32_32x32x16_bf16 v[8:23], v[80:83], a[16:19], v[8:23]
    ds_read_b128 v[72:75], v1 offset:10240
    v_exp_f32 v119, v119
    v_exp_f32 v120, v120
    v_mfma_f32_32x32x16_bf16 v[8:23], v[84:87], a[20:23], v[8:23]
    ds_read_b128 v[76:79], v1 offset:11264
    v_exp_f32 v121, v121
    v_exp_f32 v122, v122
    s_waitcnt lgkmcnt(4)
    v_mfma_f32_32x32x16_bf16 v[8:23], v[88:91], a[24:27], v[8:23]
    ds_read_b128 v[80:83], v1 offset:12288
    v_exp_f32 v123, v123
    v_mul_f32 v48, v40, v48
    v_mul_f32 v49, v41, v49
    v_mul_f32 v50, v42, v50
    v_mfma_f32_32x32x16_bf16 v[8:23], v[92:95], a[28:31], v[8:23]
    ds_read_b128 v[84:87], v1 offset:13312
    v_mul_f32 v51, v43, v51
    v_mul_f32 v52, v44, v52
    v_mul_f32 v53, v45, v53
    v_mul_f32 v54, v46, v54
    v_mul_f32 v55, v47, v55
    s_waitcnt lgkmcnt(4)
    v_mfma_f32_32x32x16_bf16 v[8:23], v[96:99], a[32:35], v[8:23]
    ds_read_b128 v[88:91], v1 offset:14336
    s_cmp_eq_u32 s18, 0
    s_cbranch_scc0 L_skip_63
    s_mov_b64 exec, 1
    buffer_load_dword v56, off, s[4:7], s84 sc1
    s_mov_b64 exec, -1
L_skip_63:
    v_mfma_f32_32x32x16_bf16 v[8:23], v[100:103], a[36:39], v[8:23]
    ds_read_b128 v[92:95], v1 offset:15360
    v_fma_f32 v116, v116, v115, v115
    v_fma_f32 v117, v117, v115, v115
    v_fma_f32 v118, v118, v115, v115
    v_fma_f32 v119, v119, v115, v115
    v_fma_f32 v120, v120, v115, v115
    s_waitcnt lgkmcnt(4)
    v_mfma_f32_32x32x16_bf16 v[8:23], v[72:75], a[40:43], v[8:23]
    ds_read_b128 v[96:99], v1 offset:16384
    v_fma_f32 v121, v121, v115, v115
    v_fma_f32 v122, v122, v115, v115
    v_fma_f32 v123, v123, v115, v115
    v_rcp_f32 v116, v116
    v_mfma_f32_32x32x16_bf16 v[8:23], v[76:79], a[44:47], v[8:23]
    ds_read_b128 v[100:103], v1 offset:17408
    v_rcp_f32 v117, v117
    v_rcp_f32 v118, v118
    s_waitcnt lgkmcnt(4)
    v_mfma_f32_32x32x16_bf16 v[8:23], v[80:83], a[48:51], v[8:23]
    ds_read_b128 v[72:75], v1 offset:18432
    v_rcp_f32 v119, v119
    v_rcp_f32 v120, v120
    v_mfma_f32_32x32x16_bf16 v[8:23], v[84:87], a[52:55], v[8:23]
    ds_read_b128 v[76:79], v1 offset:19456
    v_rcp_f32 v121, v121
    v_rcp_f32 v122, v122
    s_waitcnt lgkmcnt(4)
    v_mfma_f32_32x32x16_bf16 v[8:23], v[88:91], a[56:59], v[8:23]
    ds_read_b128 v[80:83], v1 offset:20480
    v_rcp_f32 v123, v123
    v_mul_f32 v48, v48, v116
    v_mul_f32 v49, v49, v117
    v_mul_f32 v50, v50, v118
    v_mfma_f32_32x32x16_bf16 v[8:23], v[92:95], a[60:63], v[8:23]
    ds_read_b128 v[84:87], v1 offset:21504
    v_mul_f32 v51, v51, v119
    v_mul_f32 v52, v52, v120
    v_mul_f32 v53, v53, v121
    v_mul_f32 v54, v54, v122
    v_mul_f32 v55, v55, v123
    s_waitcnt lgkmcnt(4)
    v_mfma_f32_32x32x16_bf16 v[8:23], v[96:99], a[64:67], v[8:23]
    ds_read_b128 v[88:91], v1 offset:22528
    s_waitcnt vmcnt(2)
    s_cmp_eq_u32 s18, 0
    s_cbranch_scc0 L_skip_64
    s_waitcnt vmcnt(0)
    v_readfirstlane_b32 s30, v56
    s_nop 0
    s_cmp_ge_u32 s30, 16
    s_cbranch_scc1 L_ok_65
    s_mov_b64 exec, 1
    s_mov_b32 s56, 0
L_poll_66:
    buffer_load_dword v5, off, s[4:7], s84 sc1
    s_add_u32 s56, s56, 1
    s_waitcnt vmcnt(0)
    v_readfirstlane_b32 s30, v5
    s_nop 0
    s_cmp_ge_u32 s30, 16
    s_cbranch_scc1 L_got_67
    s_cmp_lt_u32 s56, 262144
    s_cbranch_scc1 L_poll_66
    s_mov_b32 s57, 1
L_got_67:
    s_mov_b64 exec, -1
L_ok_65:
L_skip_64:
    s_barrier
    s_cmp_eq_u32 s18, 0
    s_cbranch_scc0 L_skip_68
    s_mov_b64 exec, 1
    buffer_atomic_add v4, off, s[4:7], s85
    s_mov_b64 exec, -1
L_skip_68:
    v_mfma_f32_32x32x16_bf16 v[8:23], v[100:103], a[68:71], v[8:23]
    ds_read_b128 v[92:95], v1 offset:23552
    s_mul_i32 s66, s74, 114688
    s_mul_i32 s28, s18, 28672
    s_add_u32 s66, s66, s28
    s_mul_i32 s28, s19, 7340032
    s_add_u32 s66, s66, s28
    s_add_u32 s66, s66, 26214400
    s_mul_i32 s67, s75, 114688
    s_mul_i32 s28, s18, 28672
    s_add_u32 s67, s67, s28
    s_mul_i32 s28, s19, 7340032
    s_add_u32 s67, s67, s28
    s_add_u32 s67, s67, 26214400
    buffer_load_dwordx4 a[0:3], v0, s[4:7], s66 offen sc1
    s_waitcnt lgkmcnt(4)
    v_mfma_f32_32x32x16_bf16 v[8:23], v[72:75], a[72:75], v[8:23]
    ds_read_b128 v[96:99], v1 offset:24576
    v_cvt_pk_bf16_f32 v124, v48, v49
    v_cvt_pk_bf16_f32 v125, v50, v51
    v_cvt_pk_bf16_f32 v126, v52, v53
    v_cvt_pk_bf16_f32 v127, v54, v55
    v_mfma_f32_32x32x16_bf16 v[8:23], v[76:79], a[76:79], v[8:23]
    ds_read_b128 v[100:103], v1 offset:25600
    buffer_load_dwordx4 a[4:7], v0, s[4:7], s67 offen sc1
    s_waitcnt lgkmcnt(4)
    v_mfma_f32_32x32x16_bf16 v[8:23], v[80:83], a[80:83], v[8:23]
    ds_read_b128 v[72:75], v1 offset:26624
    buffer_store_dwordx4 v[124:127], v0, s[4:7], s69 offen offset:1024 sc1
    v_mfma_f32_32x32x16_bf16 v[8:23], v[84:87], a[84:87], v[8:23]
    ds_read_b128 v[76:79], v1 offset:27648
    s_add_u32 s66, s66, 7168
    s_add_u32 s67, s67, 7168
    buffer_load_dwordx4 a[8:11], v0, s[4:7], s66 offen sc1
    s_waitcnt lgkmcnt(4)
    v_mfma_f32_32x32x16_bf16 v[8:23], v[88:91], a[88:91], v[8:23]
    ds_read_b128 v[80:83], v1 offset:28672
    v_mfma_f32_32x32x16_bf16 v[8:23], v[92:95], a[92:95], v[8:23]
    ds_read_b128 v[84:87], v1 offset:29696
    buffer_load_dwordx4 a[12:15], v0, s[4:7], s67 offen sc1
    s_waitcnt lgkmcnt(4)
    v_mfma_f32_32x32x16_bf16 v[8:23], v[96:99], a[96:99], v[8:23]
    ds_read_b128 v[88:91], v1 offset:30720
    v_mfma_f32_32x32x16_bf16 v[8:23], v[100:103], a[100:103], v[8:23]
    ds_read_b128 v[92:95], v1 offset:31744
    s_add_u32 s66, s66, 7168
    s_add_u32 s67, s67, 7168
    buffer_load_dwordx4 a[16:19], v0, s[4:7], s66 offen sc1
    s_waitcnt lgkmcnt(4)
    v_mfma_f32_32x32x16_bf16 v[8:23], v[72:75], a[104:107], v[8:23]
    ds_read_b128 v[96:99], v2 offset:28672
    v_mfma_f32_32x32x16_bf16 v[8:23], v[76:79], a[108:111], v[8:23]
    buffer_load_dwordx4 a[20:23], v0, s[4:7], s67 offen sc1
    s_waitcnt lgkmcnt(3)
    v_mfma_f32_32x32x16_bf16 v[8:23], v[80:83], a[112:115], v[8:23]
    v_mfma_f32_32x32x16_bf16 v[8:23], v[84:87], a[116:119], v[8:23]
    s_add_u32 s66, s66, 7168
    s_add_u32 s67, s67, 7168
    buffer_load_dwordx4 a[24:27], v0, s[4:7], s66 offen sc1
    s_waitcnt lgkmcnt(1)
    v_mfma_f32_32x32x16_bf16 v[8:23], v[88:91], a[120:123], v[8:23]
    v_mfma_f32_32x32x16_bf16 v[8:23], v[92:95], a[124:127], v[8:23]
    s_waitcnt lgkmcnt(0)
    v_mfma_f32_32x32x16_bf16 v[8:23], v[96:99], v[104:107], v[8:23]
    s_nop 11
    v_mul_f32 v116, v8, v114
    v_mul_f32 v117, v9, v114
    v_mul_f32 v118, v10, v114
    v_mul_f32 v119, v11, v114
    v_mul_f32 v120, v12, v114
    v_mul_f32 v121, v13, v114
    v_mul_f32 v122, v14, v114
    v_mul_f32 v123, v15, v114
    v_exp_f32 v116, v116
    buffer_load_dwordx4 a[28:31], v0, s[4:7], s67 offen sc1
    v_exp_f32 v117, v117
    v_exp_f32 v118, v118
    v_exp_f32 v119, v119
    v_exp_f32 v120, v120
    v_exp_f32 v121, v121
    v_exp_f32 v122, v122
    v_exp_f32 v123, v123
    v_mul_f32 v16, v8, v16
    v_mul_f32 v17, v9, v17
    s_sub_u32 s66, s66, 20480
    s_sub_u32 s67, s67, 20480
    buffer_load_dwordx4 a[32:35], v0, s[4:7], s66 offen sc1
    v_mul_f32 v18, v10, v18
    v_mul_f32 v19, v11, v19
    v_mul_f32 v20, v12, v20
    v_mul_f32 v21, v13, v21
    v_mul_f32 v22, v14, v22
    v_mul_f32 v23, v15, v23
    v_fma_f32 v116, v116, v115, v115
    v_fma_f32 v117, v117, v115, v115
    v_fma_f32 v118, v118, v115, v115
    buffer_load_dwordx4 a[36:39], v0, s[4:7], s67 offen sc1
    v_fma_f32 v119, v119, v115, v115
    v_fma_f32 v120, v120, v115, v115
    v_fma_f32 v121, v121, v115, v115
    v_fma_f32 v122, v122, v115, v115
    v_fma_f32 v123, v123, v115, v115
    v_rcp_f32 v116, v116
    v_rcp_f32 v117, v117
    v_rcp_f32 v118, v118
    v_rcp_f32 v119, v119
    s_add_u32 s66, s66, 7168
    s_add_u32 s67, s67, 7168
    buffer_load_dwordx4 a[40:43], v0, s[4:7], s66 offen sc1
    v_rcp_f32 v120, v120
    v_rcp_f32 v121, v121
    v_rcp_f32 v122, v122
    v_rcp_f32 v123, v123
    v_mul_f32 v16, v16, v116
    v_mul_f32 v17, v17, v117
    v_mul_f32 v18, v18, v118
    v_mul_f32 v19, v19, v119
    v_mul_f32 v20, v20, v120
    buffer_load_dwordx4 a[44:47], v0, s[4:7], s67 offen sc1
    v_mul_f32 v21, v21, v121
    v_mul_f32 v22, v22, v122
    v_mul_f32 v23, v23, v123
    v_cvt_pk_bf16_f32 v124, v16, v17
    v_cvt_pk_bf16_f32 v125, v18, v19
    v_cvt_pk_bf16_f32 v126, v20, v21
    v_cvt_pk_bf16_f32 v127, v22, v23
    buffer_store_dwordx4 v[124:127], v0, s[4:7], s69 offen offset:2048 sc1
    s_add_u32 s66, s66, 7168
    s_add_u32 s67, s67, 7168
    buffer_load_dwordx4 a[48:51], v0, s[4:7], s66 offen sc1
    buffer_load_dwordx4 a[52:55], v0, s[4:7], s67 offen sc1
    s_lshl_b32 s25, s19, 1
    s_add_u32 s25, s25, 1
    s_waitcnt vmcnt(15)
    v_mfma_f32_32x32x16_bf16 v[8:23], a[192:195], a[0:3], 0
    s_add_u32 s66, s66, 7168
    s_add_u32 s67, s67, 7168
    buffer_load_dwordx4 a[56:59], v0, s[4:7], s66 offen sc1
    v_mfma_f32_32x32x16_bf16 v[24:39], a[128:131], a[0:3], 0
    s_waitcnt vmcnt(15)
    v_mfma_f32_32x32x16_bf16 v[40:55], a[192:195], a[4:7], 0
    buffer_load_dwordx4 a[60:63], v0, s[4:7], s67 offen sc1
    v_mfma_f32_32x32x16_bf16 v[56:71], a[128:131], a[4:7], 0
    s_waitcnt vmcnt(14)
    v_mfma_f32_32x32x16_bf16 v[8:23], a[208:211], a[8:11], v[8:23]
    s_sub_u32 s66, s66, 20480
    s_sub_u32 s67, s67, 20480
    buffer_load_dwordx4 a[64:67], v0, s[4:7], s66 offen sc1
    v_mfma_f32_32x32x16_bf16 v[24:39], a[144:147], a[8:11], v[24:39]
    s_waitcnt vmcnt(14)
    v_mfma_f32_32x32x16_bf16 v[40:55], a[208:211], a[12:15], v[40:55]
    buffer_load_dwordx4 a[68:71], v0, s[4:7], s67 offen sc1
    s_cmp_eq_u32 s18, 0
    s_cbranch_scc0 L_skip_69
    s_mov_b64 exec, 1
    buffer_load_dword v100, off, s[4:7], s85 sc1
    s_mov_b64 exec, -1
L_skip_69:
    v_mfma_f32_32x32x16_bf16 v[56:71], a[144:147], a[12:15], v[56:71]
    s_waitcnt vmcnt(14)
    v_mfma_f32_32x32x16_bf16 v[8:23], a[224:227], a[16:19], v[8:23]
    s_add_u32 s66, s66, 7168
    s_add_u32 s67, s67, 7168
    buffer_load_dwordx4 a[72:75], v0, s[4:7], s66 offen sc1
    v_mfma_f32_32x32x16_bf16 v[24:39], a[160:163], a[16:19], v[24:39]
    s_waitcnt vmcnt(14)
    v_mfma_f32_32x32x16_bf16 v[40:55], a[224:227], a[20:23], v[40:55]
    buffer_load_dwordx4 a[76:79], v0, s[4:7], s67 offen sc1
    v_mfma_f32_32x32x16_bf16 v[56:71], a[160:163], a[20:23], v[56:71]
    s_waitcnt vmcnt(14)
    v_mfma_f32_32x32x16_bf16 v[8:23], a[240:243], a[24:27], v[8:23]
    s_add_u32 s66, s66, 7168
    s_add_u32 s67, s67, 7168
    buffer_load_dwordx4 a[80:83], v0, s[4:7], s66 offen sc1
    v_mfma_f32_32x32x16_bf16 v[24:39], a[176:179], a[24:27], v[24:39]
    s_waitcnt vmcnt(14)
    v_mfma_f32_32x32x16_bf16 v[40:55], a[240:243], a[28:31], v[40:55]
    buffer_load_dwordx4 a[84:87], v0, s[4:7], s67 offen sc1
    v_mfma_f32_32x32x16_bf16 v[56:71], a[176:179], a[28:31], v[56:71]
    s_waitcnt vmcnt(14)
    v_mfma_f32_32x32x16_bf16 v[8:23], a[196:199], a[32:35], v[8:23]
    s_add_u32 s66, s66, 7168
    s_add_u32 s67, s67, 7168
    buffer_load_dwordx4 a[88:91], v0, s[4:7], s66 offen sc1
    v_mfma_f32_32x32x16_bf16 v[24:39], a[132:135], a[32:35], v[24:39]
    s_waitcnt vmcnt(14)
    v_mfma_f32_32x32x16_bf16 v[40:55], a[196:199], a[36:39], v[40:55]
    buffer_load_dwordx4 a[92:95], v0, s[4:7], s67 offen sc1
    v_mfma_f32_32x32x16_bf16 v[56:71], a[132:135], a[36:39], v[56:71]
    s_waitcnt vmcnt(14)
    v_mfma_f32_32x32x16_bf16 v[8:23], a[212:215], a[40:43], v[8:23]
    s_cmp_eq_u32 s18, 0
    s_cbranch_scc0 L_skip_70
    s_waitcnt vmcnt(6)
    v_readfirstlane_b32 s30, v100
    s_nop 0
    s_cmp_ge_u32 s30, 16
    s_cbranch_scc1 L_ok_71
    s_mov_b64 exec, 1
    s_mov_b32 s56, 0
L_poll_72:
    buffer_load_dword v5, off, s[4:7], s85 sc1
    s_add_u32 s56, s56, 1
    s_waitcnt vmcnt(0)
    v_readfirstlane_b32 s30, v5
    s_nop 0
    s_cmp_ge_u32 s30, 16
    s_cbranch_scc1 L_got_73
    s_cmp_lt_u32 s56, 262144
    s_cbranch_scc1 L_poll_72
    s_mov_b32 s57, 1
L_got_73:
    s_mov_b64 exec, -1
L_ok_71:
L_skip_70:
    s_barrier
    s_sub_u32 s66, s66, 20480
    s_sub_u32 s67, s67, 20480
    buffer_load_dwordx4 a[96:99], v0, s[4:7], s66 offen sc1
    v_mfma_f32_32x32x16_bf16 v[24:39], a[148:151], a[40:43], v[24:39]
    s_waitcnt vmcnt(14)
    v_mfma_f32_32x32x16_bf16 v[40:55], a[212:215], a[44:47], v[40:55]
    buffer_load_dwordx4 a[100:103], v0, s[4:7], s67 offen sc1
    v_mfma_f32_32x32x16_bf16 v[56:71], a[148:151], a[44:47], v[56:71]
    s_waitcnt vmcnt(13)
    v_mfma_f32_32x32x16_bf16 v[8:23], a[228:231], a[48:51], v[8:23]
    s_add_u32 s66, s66, 7168
    s_add_u32 s67, s67, 7168
    buffer_load_dwordx4 a[104:107], v0, s[4:7], s66 offen sc1
    v_mfma_f32_32x32x16_bf16 v[24:39], a[164:167], a[48:51], v[24:39]
    s_waitcnt vmcnt(13)
    v_mfma_f32_32x32x16_bf16 v[40:55], a[228:231], a[52:55], v[40:55]
    buffer_load_dwordx4 a[108:111], v0, s[4:7], s67 offen sc1
    v_mfma_f32_32x32x16_bf16 v[56:71], a[164:167], a[52:55], v[56:71]
    s_waitcnt vmcnt(13)
    v_mfma_f32_32x32x16_bf16 v[8:23], a[244:247], a[56:59], v[8:23]
    s_add_u32 s66, s66, 7168
    s_add_u32 s67, s67, 7168
    buffer_load_dwordx4 a[112:115], v0, s[4:7], s66 offen sc1
    v_mfma_f32_32x32x16_bf16 v[24:39], a[180:183], a[56:59], v[24:39]
    s_waitcnt vmcnt(13)
    v_mfma_f32_32x32x16_bf16 v[40:55], a[244:247], a[60:63], v[40:55]
    buffer_load_dwordx4 a[116:119], v0, s[4:7], s67 offen sc1
    v_mfma_f32_32x32x16_bf16 v[56:71], a[180:183], a[60:63], v[56:71]
    s_barrier
    s_cmp_eq_u32 s18, 0
    s_cbranch_scc0 L_skip_74
    s_mov_b64 exec, 1
    buffer_atomic_add v4, off, s[4:7], s86
    s_mov_b64 exec, -1
L_skip_74:
    s_waitcnt vmcnt(13)
    v_mfma_f32_32x32x16_bf16 v[8:23], a[200:203], a[64:67], v[8:23]
    s_add_u32 s66, s66, 7168
    s_add_u32 s67, s67, 7168
    buffer_load_dwordx4 a[120:123], v0, s[4:7], s66 offen sc1
    v_mfma_f32_32x32x16_bf16 v[24:39], a[136:139], a[64:67], v[24:39]
    s_waitcnt vmcnt(13)
    v_mfma_f32_32x32x16_bf16 v[40:55], a[200:203], a[68:71], v[40:55]
    buffer_load_dwordx4 a[124:127], v0, s[4:7], s67 offen sc1
    v_mfma_f32_32x32x16_bf16 v[56:71], a[136:139], a[68:71], v[56:71]
    s_waitcnt vmcnt(13)
    v_mfma_f32_32x32x16_bf16 v[8:23], a[216:219], a[72:75], v[8:23]
    s_sub_u32 s66, s66, 20480
    s_sub_u32 s67, s67, 20480
    buffer_load_dwordx4 a[0:3], v0, s[4:7], s66 offen sc1
    v_mfma_f32_32x32x16_bf16 v[24:39], a[152:155], a[72:75], v[24:39]
    s_waitcnt vmcnt(13)
    v_mfma_f32_32x32x16_bf16 v[40:55], a[216:219], a[76:79], v[40:55]
    buffer_load_dwordx4 a[4:7], v0, s[4:7], s67 offen sc1
    s_cmp_eq_u32 s18, 0
    s_cbranch_scc0 L_skip_75
    s_mov_b64 exec, 1
    buffer_load_dword v100, off, s[4:7], s86 sc1
    s_mov_b64 exec, -1
L_skip_75:
    v_mfma_f32_32x32x16_bf16 v[56:71], a[152:155], a[76:79], v[56:71]
    s_waitcnt vmcnt(13)
    v_mfma_f32_32x32x16_bf16 v[8:23], a[232:235], a[80:83], v[8:23]
    s_add_u32 s66, s66, 7168
    s_add_u32 s67, s67, 7168
    buffer_load_dwordx4 a[8:11], v0, s[4:7], s66 offen sc1
    v_mfma_f32_32x32x16_bf16 v[24:39], a[168:171], a[80:83], v[24:39]
    s_waitcnt vmcnt(13)
    v_mfma_f32_32x32x16_bf16 v[40:55], a[232:235], a[84:87], v[40:55]
    buffer_load_dwordx4 a[12:15], v0, s[4:7], s67 offen sc1
    v_mfma_f32_32x32x16_bf16 v[56:71], a[168:171], a[84:87], v[56:71]
    s_xor_b32 s20, s18, 1
    s_mul_i32 s20, s20, 3
    s_add_u32 s20, s20, 0
    s_lshl_b32 s20, s20, 12
    s_add_u32 s20, s20, 98304
    v_add_u32 v96, s20, v0
    s_xor_b32 s20, s18, 2
    s_mul_i32 s20, s20, 3
    s_add_u32 s20, s20, 1
    s_lshl_b32 s20, s20, 12
    s_add_u32 s20, s20, 98304
    v_add_u32 v97, s20, v0
    s_xor_b32 s20, s18, 3
    s_mul_i32 s20, s20, 3
    s_add_u32 s20, s20, 2
    s_lshl_b32 s20, s20, 12
    s_add_u32 s20, s20, 98304
    v_add_u32 v98, s20, v0
    s_mul_i32 s20, s18, 12288
    s_add_u32 s20, s20, 98304
    v_add_u32 v99, s20, v0
    s_waitcnt vmcnt(13)
    v_mfma_f32_32x32x16_bf16 v[8:23], a[248:251], a[88:91], v[8:23]
    s_add_u32 s66, s66, 7168
    s_add_u32 s67, s67, 7168
    buffer_load_dwordx4 a[16:19], v0, s[4:7], s66 offen sc1
    v_mfma_f32_32x32x16_bf16 v[24:39], a[184:187], a[88:91], v[24:39]
    s_waitcnt vmcnt(13)
    v_mfma_f32_32x32x16_bf16 v[40:55], a[248:251], a[92:95], v[40:55]
    buffer_load_dwordx4 a[20:23], v0, s[4:7], s67 offen sc1
    v_mfma_f32_32x32x16_bf16 v[56:71], a[184:187], a[92:95], v[56:71]
    s_waitcnt vmcnt(13)
    v_mfma_f32_32x32x16_bf16 v[8:23], a[204:207], a[96:99], v[8:23]
    s_add_u32 s66, s66, 7168
    s_add_u32 s67, s67, 7168
    buffer_load_dwordx4 a[24:27], v0, s[4:7], s66 offen sc1
    v_mfma_f32_32x32x16_bf16 v[24:39], a[140:143], a[96:99], v[24:39]
    s_waitcnt vmcnt(13)
    v_mfma_f32_32x32x16_bf16 v[40:55], a[204:207], a[100:103], v[40:55]
    buffer_load_dwordx4 a[28:31], v0, s[4:7], s67 offen sc1
    v_mfma_f32_32x32x16_bf16 v[56:71], a[140:143], a[100:103], v[56:71]
    s_waitcnt vmcnt(13)
    v_mfma_f32_32x32x16_bf16 v[8:23], a[220:223], a[104:107], v[8:23]
    s_cmp_eq_u32 s18, 0
    s_cbranch_scc0 L_skip_76
    s_waitcnt vmcnt(6)
    v_readfirstlane_b32 s30, v100
    s_nop 0
    s_cmp_ge_u32 s30, 16
    s_cbranch_scc1 L_ok_77
    s_mov_b64 exec, 1
    s_mov_b32 s56, 0
L_poll_78:
    buffer_load_dword v5, off, s[4:7], s86 sc1
    s_add_u32 s56, s56, 1
    s_waitcnt vmcnt(0)
    v_readfirstlane_b32 s30, v5
    s_nop 0
    s_cmp_ge_u32 s30, 16
    s_cbranch_scc1 L_got_79
    s_cmp_lt_u32 s56, 262144
    s_cbranch_scc1 L_poll_78
    s_mov_b32 s57, 1
L_got_79:
    s_mov_b64 exec, -1
L_ok_77:
L_skip_76:
    s_barrier
    s_sub_u32 s66, s66, 20480
    s_sub_u32 s67, s67, 20480
    buffer_load_dwordx4 a[32:35], v0, s[4:7], s66 offen sc1
    v_mfma_f32_32x32x16_bf16 v[24:39], a[156:159], a[104:107], v[24:39]
    s_waitcnt vmcnt(13)
    v_mfma_f32_32x32x16_bf16 v[40:55], a[220:223], a[108:111], v[40:55]
    buffer_load_dwordx4 a[36:39], v0, s[4:7], s67 offen sc1
    v_mfma_f32_32x32x16_bf16 v[56:71], a[156:159], a[108:111], v[56:71]
    s_waitcnt vmcnt(13)
    v_mfma_f32_32x32x16_bf16 v[8:23], a[236:239], a[112:115], v[8:23]
    s_add_u32 s66, s66, 7168
    s_add_u32 s67, s67, 7168
    buffer_load_dwordx4 a[40:43], v0, s[4:7], s66 offen sc1
    v_mfma_f32_32x32x16_bf16 v[24:39], a[172:175], a[112:115], v[24:39]
    s_waitcnt vmcnt(13)
    v_mfma_f32_32x32x16_bf16 v[40:55], a[236:239], a[116:119], v[40:55]
    buffer_load_dwordx4 a[44:47], v0, s[4:7], s67 offen sc1
    v_mfma_f32_32x32x16_bf16 v[56:71], a[172:175], a[116:119], v[56:71]
    s_waitcnt vmcnt(13)
    v_mfma_f32_32x32x16_bf16 v[8:23], a[252:255], a[120:123], v[8:23]
    s_add_u32 s66, s66, 7168
    s_add_u32 s67, s67, 7168
    buffer_load_dwordx4 a[48:51], v0, s[4:7], s66 offen sc1
    v_mfma_f32_32x32x16_bf16 v[24:39], a[188:191], a[120:123], v[24:39]
    s_waitcnt vmcnt(13)
    v_mfma_f32_32x32x16_bf16 v[40:55], a[252:255], a[124:127], v[40:55]
    buffer_load_dwordx4 a[52:55], v0, s[4:7], s67 offen sc1
    v_mfma_f32_32x32x16_bf16 v[56:71], a[188:191], a[124:127], v[56:71]
    s_waitcnt vmcnt(13)
    v_mfma_f32_32x32x16_bf16 v[8:23], v[128:131], a[0:3], v[8:23]
    s_add_u32 s66, s66, 7168
    s_add_u32 s67, s67, 7168
    buffer_load_dwordx4 a[56:59], v0, s[4:7], s66 offen sc1
    v_mfma_f32_32x32x16_bf16 v[24:39], v[176:179], a[0:3], v[24:39]
    s_waitcnt vmcnt(13)
    v_mfma_f32_32x32x16_bf16 v[40:55], v[128:131], a[4:7], v[40:55]
    buffer_load_dwordx4 a[60:63], v0, s[4:7], s67 offen sc1
    v_mfma_f32_32x32x16_bf16 v[56:71], v[176:179], a[4:7], v[56:71]
    s_waitcnt vmcnt(13)
    v_mfma_f32_32x32x16_bf16 v[8:23], v[140:143], a[8:11], v[8:23]
    s_sub_u32 s66, s66, 20480
    s_sub_u32 s67, s67, 20480
    buffer_load_dwordx4 a[64:67], v0, s[4:7], s66 offen sc1
    v_mfma_f32_32x32x16_bf16 v[24:39], v[188:191], a[8:11], v[24:39]
    s_waitcnt vmcnt(13)
    v_mfma_f32_32x32x16_bf16 v[40:55], v[140:143], a[12:15], v[40:55]
    buffer_load_dwordx4 a[68:71], v0, s[4:7], s67 offen sc1
    v_mfma_f32_32x32x16_bf16 v[56:71], v[188:191], a[12:15], v[56:71]
    s_waitcnt vmcnt(13)
    v_mfma_f32_32x32x16_bf16 v[8:23], v[152:155], a[16:19], v[8:23]
    s_add_u32 s66, s66, 7168
    s_add_u32 s67, s67, 7168
    buffer_load_dwordx4 a[72:75], v0, s[4:7], s66 offen sc1
    v_mfma_f32_32x32x16_bf16 v[24:39], v[200:203], a[16:19], v[24:39]
    s_waitcnt vmcnt(13)
    v_mfma_f32_32x32x16_bf16 v[40:55], v[152:155], a[20:23], v[40:55]
    buffer_load_dwordx4 a[76:79], v0, s[4:7], s67 offen sc1
    v_mfma_f32_32x32x16_bf16 v[56:71], v[200:203], a[20:23], v[56:71]
    s_waitcnt vmcnt(13)
    v_mfma_f32_32x32x16_bf16 v[8:23], v[164:167], a[24:27], v[8:23]
    s_add_u32 s66, s66, 7168
    s_add_u32 s67, s67, 7168
    buffer_load_dwordx4 a[80:83], v0, s[4:7], s66 offen sc1
    v_mfma_f32_32x32x16_bf16 v[24:39], v[212:215], a[24:27], v[24:39]
    s_waitcnt vmcnt(13)
    v_mfma_f32_32x32x16_bf16 v[40:55], v[164:167], a[28:31], v[40:55]
    buffer_load_dwordx4 a[84:87], v0, s[4:7], s67 offen sc1
    v_mfma_f32_32x32x16_bf16 v[56:71], v[212:215], a[28:31], v[56:71]
    s_waitcnt vmcnt(13)
    v_mfma_f32_32x32x16_bf16 v[8:23], v[132:135], a[32:35], v[8:23]
    s_add_u32 s66, s66, 7168
    s_add_u32 s67, s67, 7168
    buffer_load_dwordx4 a[88:91], v0, s[4:7], s66 offen sc1
    v_mfma_f32_32x32x16_bf16 v[24:39], v[180:183], a[32:35], v[24:39]
    s_waitcnt vmcnt(13)
    v_mfma_f32_32x32x16_bf16 v[40:55], v[132:135], a[36:39], v[40:55]
    buffer_load_dwordx4 a[92:95], v0, s[4:7], s67 offen sc1
    v_mfma_f32_32x32x16_bf16 v[56:71], v[180:183], a[36:39], v[56:71]
    s_waitcnt vmcnt(13)
    v_mfma_f32_32x32x16_bf16 v[8:23], v[144:147], a[40:43], v[8:23]
    v_mfma_f32_32x32x16_bf16 v[24:39], v[192:195], a[40:43], v[24:39]
    s_waitcnt vmcnt(12)
    v_mfma_f32_32x32x16_bf16 v[40:55], v[144:147], a[44:47], v[40:55]
    v_mfma_f32_32x32x16_bf16 v[56:71], v[192:195], a[44:47], v[56:71]
    s_waitcnt vmcnt(11)
    v_mfma_f32_32x32x16_bf16 v[8:23], v[156:159], a[48:51], v[8:23]
    v_mfma_f32_32x32x16_bf16 v[24:39], v[204:207], a[48:51], v[24:39]
    s_waitcnt vmcnt(10)
    v_mfma_f32_32x32x16_bf16 v[40:55], v[156:159], a[52:55], v[40:55]
    v_mfma_f32_32x32x16_bf16 v[56:71], v[204:207], a[52:55], v[56:71]
    s_waitcnt vmcnt(9)
    v_mfma_f32_32x32x16_bf16 v[8:23], v[168:171], a[56:59], v[8:23]
    v_mfma_f32_32x32x16_bf16 v[24:39], v[216:219], a[56:59], v[24:39]
    s_waitcnt vmcnt(8)
    v_mfma_f32_32x32x16_bf16 v[40:55], v[168:171], a[60:63], v[40:55]
    v_mfma_f32_32x32x16_bf16 v[56:71], v[216:219], a[60:63], v[56:71]
    s_waitcnt vmcnt(7)
    v_mfma_f32_32x32x16_bf16 v[8:23], v[136:139], a[64:67], v[8:23]
    v_mfma_f32_32x32x16_bf16 v[24:39], v[184:187], a[64:67], v[24:39]
    s_waitcnt vmcnt(6)
    v_mfma_f32_32x32x16_bf16 v[40:55], v[136:139], a[68:71], v[40:55]
    v_mfma_f32_32x32x16_bf16 v[56:71], v[184:187], a[68:71], v[56:71]
    s_lshl_b32 s25, s19, 1
    s_add_u32 s68, s25, 2
    s_lshl_b32 s78, s68, 21
    s_lshl_b32 s21, s74, 15
    s_add_u32 s78, s78, s21
    s_lshl_b32 s21, s76, 11
    s_add_u32 s78, s78, s21
    s_add_u32 s78, s78, 10485760
    s_lshl_b32 s79, s68, 18
    s_lshl_b32 s22, s74, 12
    s_add_u32 s79, s79, s22
    s_lshl_b32 s22, s76, 8
    s_add_u32 s79, s79, s22
    s_add_u32 s79, s79, 18874368
    s_waitcnt vmcnt(4)
    v_mfma_f32_32x32x16_bf16 v[56:71], v[196:199], a[76:79], v[56:71]
    s_waitcnt vmcnt(2)
    v_mfma_f32_32x32x16_bf16 v[56:71], v[208:211], a[84:87], v[56:71]
    s_waitcnt vmcnt(0)
    v_mfma_f32_32x32x16_bf16 v[56:71], v[220:223], a[92:95], v[56:71]
    v_mfma_f32_32x32x16_bf16 v[40:55], v[148:151], a[76:79], v[40:55]
    v_lshlrev_b32 v80, 16, v244
    v_and_b32 v81, 4294901760, v244
    v_lshlrev_b32 v82, 16, v245
    v_and_b32 v83, 4294901760, v245
    v_lshlrev_b32 v84, 16, v246
    v_and_b32 v85, 4294901760, v246
    v_mfma_f32_32x32x16_bf16 v[40:55], v[160:163], a[84:87], v[40:55]
    v_lshlrev_b32 v86, 16, v247
    v_and_b32 v87, 4294901760, v247
    v_lshlrev_b32 v88, 16, v248
    v_and_b32 v89, 4294901760, v248
    v_lshlrev_b32 v90, 16, v249
    v_and_b32 v91, 4294901760, v249
    v_mfma_f32_32x32x16_bf16 v[40:55], v[172:175], a[92:95], v[40:55]
    v_lshlrev_b32 v92, 16, v250
    v_and_b32 v93, 4294901760, v250
    v_lshlrev_b32 v94, 16, v251
    v_and_b32 v95, 4294901760, v251
    ds_write_b128 v98, v[56:59]
    ds_write_b128 v98, v[60:63] offset:1024
    v_mfma_f32_32x32x16_bf16 v[24:39], v[196:199], a[72:75], v[24:39]
    ds_write_b128 v98, v[64:67] offset:2048
    ds_write_b128 v98, v[68:71] offset:3072
    v_mfma_f32_32x32x16_bf16 v[24:39], v[208:211], a[80:83], v[24:39]
    v_mfma_f32_32x32x16_bf16 v[24:39], v[220:223], a[88:91], v[24:39]
    s_nop 0
    ds_write_b128 v97, v[40:43]
    ds_write_b128 v97, v[44:47] offset:1024
    v_mfma_f32_32x32x16_bf16 v[8:23], v[148:151], a[72:75], v[8:23]
    ds_write_b128 v97, v[48:51] offset:2048
    ds_write_b128 v97, v[52:55] offset:3072
    v_mfma_f32_32x32x16_bf16 v[8:23], v[160:163], a[80:83], v[8:23]
    v_mfma_f32_32x32x16_bf16 v[8:23], v[172:175], a[88:91], v[8:23]
    s_nop 3
    ds_write_b128 v96, v[24:27]
    ds_write_b128 v96, v[28:31] offset:1024
    ds_write_b128 v96, v[32:35] offset:2048
    ds_write_b128 v96, v[36:39] offset:3072
    s_waitcnt lgkmcnt(0)
    s_barrier
    ds_read_b128 v[24:27], v99
    ds_read_b128 v[28:31], v99 offset:1024
    ds_read_b128 v[32:35], v99 offset:2048
    ds_read_b128 v[36:39], v99 offset:3072
    ds_read_b128 v[40:43], v99 offset:4096
    ds_read_b128 v[44:47], v99 offset:5120
    ds_read_b128 v[48:51], v99 offset:6144
    ds_read_b128 v[52:55], v99 offset:7168
    ds_read_b128 v[56:59], v99 offset:8192
    ds_read_b128 v[60:63], v99 offset:9216
    ds_read_b128 v[64:67], v99 offset:10240
    ds_read_b128 v[68:71], v99 offset:11264
    v_pk_add_f32 v[8:9], v[8:9], v[80:81]
    v_pk_add_f32 v[10:11], v[10:11], v[82:83]
    v_pk_add_f32 v[12:13], v[12:13], v[84:85]
    v_pk_add_f32 v[14:15], v[14:15], v[86:87]
    v_pk_add_f32 v[16:17], v[16:17], v[88:89]
    v_pk_add_f32 v[18:19], v[18:19], v[90:91]
    v_pk_add_f32 v[20:21], v[20:21], v[92:93]
    v_pk_add_f32 v[22:23], v[22:23], v[94:95]
    s_waitcnt lgkmcnt(11)
    v_pk_add_f32 v[8:9], v[8:9], v[24:25]
    v_pk_add_f32 v[10:11], v[10:11], v[26:27]
    s_waitcnt lgkmcnt(10)
    v_pk_add_f32 v[12:13], v[12:13], v[28:29]
    v_pk_add_f32 v[14:15], v[14:15], v[30:31]
    s_waitcnt lgkmcnt(9)
    v_pk_add_f32 v[16:17], v[16:17], v[32:33]
    v_pk_add_f32 v[18:19], v[18:19], v[34:35]
    s_waitcnt lgkmcnt(8)
    v_pk_add_f32 v[20:21], v[20:21], v[36:37]
    v_pk_add_f32 v[22:23], v[22:23], v[38:39]
    s_waitcnt lgkmcnt(7)
    v_pk_add_f32 v[8:9], v[8:9], v[40:41]
    v_pk_add_f32 v[10:11], v[10:11], v[42:43]
    s_waitcnt lgkmcnt(6)
    v_pk_add_f32 v[12:13], v[12:13], v[44:45]
    v_pk_add_f32 v[14:15], v[14:15], v[46:47]
    s_waitcnt lgkmcnt(5)
    v_pk_add_f32 v[16:17], v[16:17], v[48:49]
    v_pk_add_f32 v[18:19], v[18:19], v[50:51]
    s_waitcnt lgkmcnt(4)
    v_pk_add_f32 v[20:21], v[20:21], v[52:53]
    v_pk_add_f32 v[22:23], v[22:23], v[54:55]
    s_waitcnt lgkmcnt(3)
    v_pk_add_f32 v[8:9], v[8:9], v[56:57]
    v_pk_add_f32 v[10:11], v[10:11], v[58:59]
    s_waitcnt lgkmcnt(2)
    v_pk_add_f32 v[12:13], v[12:13], v[60:61]
    v_pk_add_f32 v[14:15], v[14:15], v[62:63]
    s_waitcnt lgkmcnt(1)
    v_pk_add_f32 v[16:17], v[16:17], v[64:65]
    v_pk_add_f32 v[18:19], v[18:19], v[66:67]
    s_waitcnt lgkmcnt(0)
    v_pk_add_f32 v[20:21], v[20:21], v[68:69]
    v_pk_add_f32 v[22:23], v[22:23], v[70:71]
    v_cvt_pk_bf16_f32 v244, v8, v9
    v_cvt_pk_bf16_f32 v245, v10, v11
    v_cvt_pk_bf16_f32 v246, v12, v13
    v_cvt_pk_bf16_f32 v247, v14, v15
    v_cvt_pk_bf16_f32 v248, v16, v17
    v_cvt_pk_bf16_f32 v249, v18, v19
    v_cvt_pk_bf16_f32 v250, v20, v21
    v_cvt_pk_bf16_f32 v251, v22, v23
    s_cmp_eq_u32 s19, 0
    s_cbranch_scc0 L_skip_80
    buffer_store_dwordx4 v[244:247], v0, s[4:7], s78 offen sc1
    buffer_store_dwordx4 v[248:251], v0, s[4:7], s78 offen offset:1024 sc1
    v_pk_mul_f32 v[228:229], v[8:9], v[8:9]
    v_pk_mul_f32 v[230:231], v[10:11], v[10:11]
    v_pk_add_f32 v[224:225], v[8:9], v[10:11]
    v_pk_add_f32 v[226:227], v[12:13], v[14:15]
    v_pk_fma_f32 v[228:229], v[12:13], v[12:13], v[228:229]
    v_pk_fma_f32 v[230:231], v[14:15], v[14:15], v[230:231]
    v_pk_fma_f32 v[228:229], v[16:17], v[16:17], v[228:229]
    v_pk_add_f32 v[224:225], v[224:225], v[16:17]
    v_pk_add_f32 v[226:227], v[226:227], v[18:19]
    v_pk_fma_f32 v[230:231], v[18:19], v[18:19], v[230:231]
    v_pk_fma_f32 v[228:229], v[20:21], v[20:21], v[228:229]
    v_pk_add_f32 v[224:225], v[224:225], v[20:21]
    v_pk_add_f32 v[226:227], v[226:227], v[22:23]
    v_pk_fma_f32 v[230:231], v[22:23], v[22:23], v[230:231]
    v_pk_add_f32 v[224:225], v[224:225], v[226:227]
    v_pk_add_f32 v[228:229], v[228:229], v[230:231]
    v_add_f32 v240, v224, v225
    v_add_f32 v241, v228, v229
    v_mov_b32 v224, v240
    v_mov_b32 v225, v241
    s_nop 0
    v_permlane32_swap_b32 v240, v224
    v_permlane32_swap_b32 v241, v225
    v_add_f32 v240, v240, v224
    v_add_f32 v241, v241, v225
    v_lshrrev_b32 v224, 1, v7
    buffer_store_dwordx2 v[240:241], v224, s[4:7], s79 offen sc1
L_skip_80:
    s_cmp_eq_u32 s19, 1
    s_cbranch_scc0 L_skip_81
    v_lshrrev_b32 v224, 4, v7
    v_lshlrev_b32 v224, 10, v224
    v_lshrrev_b32 v225, 5, v3
    v_lshlrev_b32 v225, 3, v225
    v_add_u32 v224, v224, v225
    s_lshl_b32 s20, s74, 15
    s_lshl_b32 s21, s76, 6
    s_add_u32 s20, s20, s21
    v_lshrrev_b32 v225, 5, v3
    v_lshlrev_b32 v225, 3, v225
    v_add_u32 v224, v224, v225
    v_permlane32_swap_b32 v244, v246
    v_permlane32_swap_b32 v245, v247
    v_permlane32_swap_b32 v248, v250
    v_permlane32_swap_b32 v249, v251
    buffer_store_dwordx4 v[244:247], v224, s[8:11], s20 offen
    buffer_store_dwordx4 v[248:251], v224, s[8:11], s20 offen offset:32
L_skip_81:
    s_cmp_eq_u32 s19, 0
    s_cbranch_scc0 L_skip_82
    s_mul_i32 s58, s19, 28672
    s_lshl_b32 s31, s16, 8
    s_add_u32 s58, s58, s31
    s_add_u32 s58, s58, 28672
    s_mul_i32 s23, s17, 98304
    s_lshl_b32 s24, s18, 14
    s_add_u32 s24, s24, 32768
    s_add_u32 s23, s23, s24
    s_add_u32 s23, s23, 1048576
    s_mov_b32 m0, s24
    s_nop 0
    buffer_load_dwordx4 v0, s[4:7], s23 offen sc1 lds
    buffer_load_dwordx4 v0, s[4:7], s23 offen offset:1024 sc1 lds
    buffer_load_dwordx4 v0, s[4:7], s23 offen offset:2048 sc1 lds
    buffer_load_dwordx4 v0, s[4:7], s23 offen offset:3072 sc1 lds
    s_add_u32 s23, s23, 4096
    s_add_u32 s24, s24, 4096
    s_mov_b32 m0, s24
    s_nop 0
    buffer_load_dwordx4 v0, s[4:7], s23 offen sc1 lds
    buffer_load_dwordx4 v0, s[4:7], s23 offen offset:1024 sc1 lds
    buffer_load_dwordx4 v0, s[4:7], s23 offen offset:2048 sc1 lds
    buffer_load_dwordx4 v0, s[4:7], s23 offen offset:3072 sc1 lds
    s_add_u32 s23, s23, 4096
    s_add_u32 s24, s24, 4096
    s_mov_b32 m0, s24
    s_nop 0
    buffer_load_dwordx4 v0, s[4:7], s23 offen sc1 lds
    buffer_load_dwordx4 v0, s[4:7], s23 offen offset:1024 sc1 lds
    buffer_load_dwordx4 v0, s[4:7], s23 offen offset:2048 sc1 lds
    s_waitcnt vmcnt(11)
    s_waitcnt lgkmcnt(0)
    s_barrier
    s_cmp_eq_u32 s18, 0
    s_cbranch_scc0 L_skip_83
    s_mov_b64 exec, 1
    buffer_atomic_add v4, off, s[4:7], s58
    s_mov_b64 exec, -1
L_skip_83:
    buffer_load_dwordx4 v0, s[4:7], s23 offen offset:3072 sc1 lds
    s_add_u32 s23, s23, 4096
    s_add_u32 s24, s24, 4096
    s_mov_b32 m0, s24
    s_nop 0
    buffer_load_dwordx4 v0, s[4:7], s23 offen sc1 lds
    buffer_load_dwordx4 v0, s[4:7], s23 offen offset:1024 sc1 lds
    buffer_load_dwordx4 v0, s[4:7], s23 offen offset:2048 sc1 lds
    buffer_load_dwordx4 v0, s[4:7], s23 offen offset:3072 sc1 lds
    s_cmp_lg_u32 s18, 0
    s_cbranch_scc0 L_skip_84
    s_sub_u32 s20, s18, 1
    s_mul_i32 s22, s20, 11264
    s_mul_i32 s21, s17, 98304
    s_add_u32 s21, s21, s22
    s_add_u32 s21, s21, 1048576
    s_mov_b32 m0, s22
    s_nop 0
    buffer_load_dwordx4 v0, s[4:7], s21 offen sc1 lds
    buffer_load_dwordx4 v0, s[4:7], s21 offen offset:1024 sc1 lds
    buffer_load_dwordx4 v0, s[4:7], s21 offen offset:2048 sc1 lds
    buffer_load_dwordx4 v0, s[4:7], s21 offen offset:3072 sc1 lds
    s_add_u32 s21, s21, 4096
    s_add_u32 s22, s22, 4096
    s_mov_b32 m0, s22
    s_nop 0
    buffer_load_dwordx4 v0, s[4:7], s21 offen sc1 lds
    buffer_load_dwordx4 v0, s[4:7], s21 offen offset:1024 sc1 lds
    buffer_load_dwordx4 v0, s[4:7], s21 offen offset:2048 sc1 lds
    buffer_load_dwordx4 v0, s[4:7], s21 offen offset:3072 sc1 lds
    s_add_u32 s21, s21, 4096
    s_add_u32 s22, s22, 4096
    s_mov_b32 m0, s22
    s_nop 0
    buffer_load_dwordx4 v0, s[4:7], s21 offen sc1 lds
    buffer_load_dwordx4 v0, s[4:7], s21 offen offset:1024 sc1 lds
    buffer_load_dwordx4 v0, s[4:7], s21 offen offset:2048 sc1 lds
L_skip_84:
    s_cmp_eq_u32 s18, 0
    s_cbranch_scc0 L_skip_85
    s_mov_b64 exec, 1
    s_mov_b32 s56, 0
L_poll_86:
    buffer_load_dword v5, off, s[4:7], s58 sc1
    s_add_u32 s56, s56, 1
    s_waitcnt vmcnt(0)
    v_readfirstlane_b32 s30, v5
    s_nop 0
    s_cmp_ge_u32 s30, 16
    s_cbranch_scc1 L_got_87
    s_cmp_lt_u32 s56, 262144
    s_cbranch_scc1 L_poll_86
    s_mov_b32 s57, 1
L_got_87:
    s_mov_b64 exec, -1
L_skip_85:
    s_barrier
L_skip_82:
    s_add_u32 s19, s19, 1
    s_cmp_lt_u32 s19, 2
    s_cbranch_scc1 L_layer
L_loop_end:
L_fin:
    s_cmp_eq_u32 s18, 0
    s_cbranch_scc0 L_skip_88
    s_mov_b64 exec, 1
    v_mov_b32 v5, s57
    s_cmp_lg_u32 s57, 0
    s_cbranch_scc0 L_noerr_89
    buffer_store_dword v5, off, s[52:55], 0 offset:4
L_noerr_89:
    s_mov_b64 exec, -1
L_skip_88:
    s_waitcnt vmcnt(0)
L_end:
    s_endpgm
L_codeend:
.section .rodata,"a"
.p2align 6
.amdhsa_kernel interleave_layers__linear_attn_block__glu_gated_swiglu__prompt_kernel
  .amdhsa_next_free_vgpr 512
  .amdhsa_next_free_sgpr 102
  .amdhsa_accum_offset 256
  .amdhsa_group_segment_fixed_size 0
  .amdhsa_kernarg_size 80
  .amdhsa_user_sgpr_count 2
  .amdhsa_user_sgpr_kernarg_segment_ptr 1
  .amdhsa_system_sgpr_workgroup_id_x 1
  .amdhsa_float_denorm_mode_32 3
.end_amdhsa_kernel
```
